```python
import torch

def _softmax(x, axis=-1):
    return torch.softmax(x, dim=axis)
def _gelu(x):
    return torch.nn.functional.gelu(x, approximate="tanh")
def _silu(x):
    return torch.nn.functional.silu(x)
def _sigmoid(x):
    return torch.sigmoid(x)
def _layernorm(x, axis=-1, eps=1e-5):
    m = x.mean(dim=axis, keepdim=True)
    v = x.var(dim=axis, keepdim=True, unbiased=False)
    return (x - m) / torch.sqrt(v + eps)
def _scatter_add(tgt, idx, src, axis=0):
    return tgt.clone().index_add_(axis, idx, src)
def _segment_sum(src, seg, n):
    out = torch.zeros((n,) + src.shape[1:], dtype=src.dtype)
    return out.index_add_(0, seg, src)
def _pad(x, pw):
    flat = tuple(v for pair in reversed(pw) for v in pair)
    return torch.nn.functional.pad(x, flat)

kernel_name = 'gated_mix__ssm_conv_s5__dense_activation_relu__prompt'

def setup_inputs():

    _w = (lambda a: (lambda t: t.to(torch.bfloat16) if t.is_floating_point() else t)(torch.as_tensor(a)))
    def _A_setup():
        B, S, D = 1, 2048, 640
        P = D
        Lambda_re = -0.5 * (lambda _x: torch.exp(torch.as_tensor(_x)))((lambda *s: torch.randn(*s, dtype=torch.bfloat16) * 0.8)(P))
        Lambda_im = (lambda *s: torch.randn(*s, dtype=torch.bfloat16) * 0.8)(P) * 1.0
        B_re = (lambda *s: torch.randn(*s, dtype=torch.bfloat16) * 0.8)(P, D) * (D ** -0.5)
        B_im = (lambda *s: torch.randn(*s, dtype=torch.bfloat16) * 0.8)(P, D) * (D ** -0.5)
        C_re = (lambda *s: torch.randn(*s, dtype=torch.bfloat16) * 0.8)(D, P) * (P ** -0.5)
        C_im = (lambda *s: torch.randn(*s, dtype=torch.bfloat16) * 0.8)(D, P) * (P ** -0.5)
        log_dt = (lambda *s: torch.randn(*s, dtype=torch.bfloat16) * 0.8)(P) * 0.3 - 2.0
        Dskip = (lambda *s: torch.randn(*s, dtype=torch.bfloat16) * 0.8)(D)
        return {
            "x": _w((lambda *s: torch.randn(*s, dtype=torch.bfloat16) * 0.05)(B, S, D)),
            "Lambda_re": _w(Lambda_re),
            "Lambda_im": _w(Lambda_im),
            "B_re": _w(B_re),
            "B_im": _w(B_im),
            "C_re": _w(C_re),
            "C_im": _w(C_im),
            "log_dt": _w(log_dt),
            "Dskip": _w(Dskip),
        }
    _A_in = _A_setup()

    def _B_setup():
        B, S, D, Dff = 1, 2048, 640, 1728
        return {
            "x": _w((lambda *s: torch.randn(*s, dtype=torch.bfloat16) * 0.05)(B, S, D)),
            "w1": _w((lambda *s: torch.randn(*s, dtype=torch.bfloat16) * 0.05)(D, Dff)),
            "w2": _w((lambda *s: torch.randn(*s, dtype=torch.bfloat16) * 0.05)(Dff, D)),
        }
    _B_in = _B_setup()

    return {
        "A_x": _A_in["x"],
        "A_Lambda_re": _A_in["Lambda_re"],
        "A_Lambda_im": _A_in["Lambda_im"],
        "A_B_re": _A_in["B_re"],
        "A_B_im": _A_in["B_im"],
        "A_C_re": _A_in["C_re"],
        "A_C_im": _A_in["C_im"],
        "A_log_dt": _A_in["log_dt"],
        "A_Dskip": _A_in["Dskip"],
        "B_x": _B_in["x"],
        "B_w1": _B_in["w1"],
        "B_w2": _B_in["w2"],
        "gate_w": _w((lambda *s: torch.randn(*s, dtype=torch.bfloat16) * 0.05)(640) * 16.0),
    }

def reference(A_x, A_Lambda_re, A_Lambda_im, A_B_re, A_B_im, A_C_re, A_C_im, A_log_dt, A_Dskip, B_x, B_w1, B_w2, gate_w):
    def _A_ref(x, Lambda_re, Lambda_im, B_re, B_im, C_re, C_im, log_dt, Dskip):
        Bsz, L, H = x.shape
        Lam = Lambda_re + 1j * Lambda_im
        Bmat = B_re + 1j * B_im
        Cmat = C_re + 1j * C_im
        dt = torch.exp(log_dt)
        Lam_bar = torch.exp(dt * Lam)
        B_bar = ((Lam_bar - 1.0) / Lam)[:, None] * Bmat
        Bu = torch.einsum("bld,pd->blp", x + 0j, B_bar)
        h = torch.zeros_like(Bu[:, 0, :])
        hs = []
        for t in range(L):
            h = Lam_bar[None, :] * h + Bu[:, t, :]
            hs.append(h)
        hseq = torch.stack(hs, 1)
        y = 2.0 * torch.einsum("blp,dp->bld", hseq, Cmat).real + x * Dskip[None, None, :]
        return y

    def _B_ref(x, w1, w2):
        h = torch.einsum("bsd,df->bsf", x, w1)
        zero = torch.zeros_like(h)
        h = torch.maximum(h, zero)
        return torch.einsum("bsf,fd->bsd", h, w2)

    x = A_x
    g = _sigmoid((x * gate_w).sum(-1, keepdims=True))
    a = _A_ref(x, A_Lambda_re, A_Lambda_im, A_B_re, A_B_im, A_C_re, A_C_im, A_log_dt, A_Dskip)
    b = _B_ref(x, B_w1, B_w2)
    return g * a + (1 - g) * b
```

```asm
; @launch kernel=k1_kernel grid=(384,1,1) block=(256,1,1) lds=77824
; @launch kernel=k2_kernel grid=(448,1,1) block=(128,1,1) lds=0
; @launch kernel=k3_kernel grid=(256,1,1) block=(256,1,1) lds=90112
.amdgcn_target "amdgcn-amd-amdhsa--gfx950"
.text
.globl k1_kernel
.p2align 8
.type k1_kernel,@function
k1_kernel:
    s_cmp_ge_u32 s2, 384
    s_cbranch_scc1 K1_END
    s_load_dwordx16 s[44:59], s[0:1], 0
    s_load_dwordx2 s[60:61], s[0:1], 80
    s_load_dwordx2 s[62:63], s[0:1], 120
    v_lshrrev_b32 v1, 6, v0
    v_and_b32 v2, 63, v0
    v_lshrrev_b32 v3, 3, v0
    s_waitcnt lgkmcnt(0)
    s_mov_b32 s4, s44
    s_and_b32 s5, s45, 0xffff
    s_mov_b32 s6, 2621440
    s_mov_b32 s7, 0x00020000
    s_cmp_ge_u32 s2, 160
    s_cbranch_scc1 K1_FFN_SETUP
    s_and_b32 s36, s2, 15
    s_lshr_b32 s37, s2, 4
    s_mov_b32 s8, s50
    s_and_b32 s9, s51, 0xffff
    s_mov_b32 s10, 819200
    s_mov_b32 s11, 0x00020000
    s_mov_b32 s12, s52
    s_and_b32 s13, s53, 0xffff
    s_mov_b32 s14, 819200
    s_mov_b32 s15, 0x00020000
    s_mov_b32 s16, s62
    s_and_b32 s17, s63, 0xffff
    s_mov_b32 s18, 5242880
    s_mov_b32 s19, 0x00020000
    s_add_u32 s64, s62, 5242880
    s_addc_u32 s65, s63, 0
    s_mov_b32 s20, s64
    s_and_b32 s21, s65, 0xffff
    s_mov_b32 s22, 327680
    s_mov_b32 s23, 0x00020000
    s_mov_b32 s24, s46
    s_and_b32 s25, s47, 0xffff
    s_mov_b32 s26, 1280
    s_mov_b32 s27, 0x00020000
    s_mov_b32 s28, s48
    s_and_b32 s29, s49, 0xffff
    s_mov_b32 s30, 1280
    s_mov_b32 s31, 0x00020000
    s_mov_b32 s32, s58
    s_and_b32 s33, s59, 0xffff
    s_mov_b32 s34, 1280
    s_mov_b32 s35, 0x00020000
    s_lshl_b32 s41, s37, 6
    v_add_u32 v8, s41, v3
    v_mul_u32_u24 v8, 1280, v8
    v_and_b32 v9, 7, v0
    v_lshlrev_b32 v9, 4, v9
    v_add_u32 v8, v8, v9
    v_add_u32 v10, 40960, v8
    s_mov_b32 s42, 128
    s_mov_b32 s43, 0
    s_branch K1_COMMON
K1_FFN_SETUP:
    s_sub_u32 s41, s2, 160
    s_and_b32 s36, s41, 15
    s_lshr_b32 s37, s41, 4
    s_mov_b32 s8, s60
    s_and_b32 s9, s61, 0xffff
    s_mov_b32 s10, 2211840
    s_mov_b32 s11, 0x00020000
    s_add_u32 s64, s62, 6291456
    s_addc_u32 s65, s63, 0
    s_mov_b32 s16, s64
    s_and_b32 s17, s65, 0xffff
    s_mov_b32 s18, 7077888
    s_mov_b32 s19, 0x00020000
    v_lshrrev_b32 v8, 4, v0
    v_mul_u32_u24 v8, 3456, v8
    v_and_b32 v9, 15, v0
    v_lshlrev_b32 v9, 4, v9
    v_add_u32 v8, v8, v9
    s_lshl_b32 s41, s37, 8
    v_add_u32 v8, s41, v8
    v_add_u32 v9, 55296, v8
    v_add_u32 v10, 110592, v8
    v_add_u32 v11, 165888, v8
    s_mov_b32 s42, 221184
    s_mov_b32 s43, 1
K1_COMMON:
    s_lshl_b32 s41, s36, 7
    v_add_u32 v4, s41, v3
    v_mul_u32_u24 v4, 1280, v4
    v_and_b32 v5, 7, v0
    v_lshlrev_b32 v5, 4, v5
    v_add_u32 v4, v4, v5
    v_add_u32 v5, 40960, v4
    v_add_u32 v6, 81920, v4
    v_add_u32 v7, 122880, v4
    v_mul_u32_u24 v12, 144, v3
    v_and_b32 v13, 7, v0
    v_lshlrev_b32 v13, 4, v13
    v_add_u32 v12, v12, v13
    v_add_u32 v56, 18432, v12
    v_lshrrev_b32 v13, 4, v0
    v_mul_u32_u24 v13, 320, v13
    v_and_b32 v14, 15, v0
    v_lshlrev_b32 v14, 4, v14
    v_add_u32 v13, v13, v14
    v_add_u32 v13, 18432, v13
    v_lshrrev_b32 v14, 1, v1
    v_and_b32 v15, 1, v1
    v_and_b32 v16, 31, v2
    v_bfe_u32 v17, v16, 2, 1
    v_lshlrev_b32 v17, 5, v17
    v_lshrrev_b32 v18, 3, v16
    v_lshl_add_u32 v17, v18, 2, v17
    v_and_b32 v18, 3, v16
    v_add_u32 v17, v17, v18
    s_cmp_eq_u32 s43, 1
    s_cselect_b32 s41, -1, 0
    v_mov_b32 v18, s41
    v_cmp_ne_u32 vcc, 0, v18
    s_nop 1
    v_cndmask_b32 v17, v17, v16, vcc
    v_lshl_add_u32 v17, v14, 6, v17
    v_mul_u32_u24 v17, 144, v17
    v_lshrrev_b32 v18, 5, v2
    v_lshl_add_u32 v17, v18, 4, v17
    v_lshl_add_u32 v19, v15, 6, v16
    v_mul_u32_u24 v19, 144, v19
    v_lshl_add_u32 v19, v18, 4, v19
    v_add_u32 v18, 18432, v19
    v_lshrrev_b32 v20, 5, v2
    v_lshlrev_b32 v20, 3, v20
    v_bfe_u32 v21, v2, 2, 2
    v_add_u32 v20, v20, v21
    v_mul_u32_u24 v20, 320, v20
    v_bfe_u32 v21, v2, 4, 1
    v_lshlrev_b32 v21, 4, v21
    v_and_b32 v22, 3, v2
    v_lshl_add_u32 v21, v22, 2, v21
    v_lshl_add_u32 v21, v15, 6, v21
    v_lshl_add_u32 v20, v21, 1, v20
    v_add_u32 v19, 18432, v20
    v_mov_b32 v64, 0
    v_mov_b32 v65, 0
    v_mov_b32 v66, 0
    v_mov_b32 v67, 0
    v_mov_b32 v68, 0
    v_mov_b32 v69, 0
    v_mov_b32 v70, 0
    v_mov_b32 v71, 0
    v_mov_b32 v72, 0
    v_mov_b32 v73, 0
    v_mov_b32 v74, 0
    v_mov_b32 v75, 0
    v_mov_b32 v76, 0
    v_mov_b32 v77, 0
    v_mov_b32 v78, 0
    v_mov_b32 v79, 0
    v_mov_b32 v80, 0
    v_mov_b32 v81, 0
    v_mov_b32 v82, 0
    v_mov_b32 v83, 0
    v_mov_b32 v84, 0
    v_mov_b32 v85, 0
    v_mov_b32 v86, 0
    v_mov_b32 v87, 0
    v_mov_b32 v88, 0
    v_mov_b32 v89, 0
    v_mov_b32 v90, 0
    v_mov_b32 v91, 0
    v_mov_b32 v92, 0
    v_mov_b32 v93, 0
    v_mov_b32 v94, 0
    v_mov_b32 v95, 0
    v_mov_b32 v96, 0
    v_mov_b32 v97, 0
    v_mov_b32 v98, 0
    v_mov_b32 v99, 0
    v_mov_b32 v100, 0
    v_mov_b32 v101, 0
    v_mov_b32 v102, 0
    v_mov_b32 v103, 0
    v_mov_b32 v104, 0
    v_mov_b32 v105, 0
    v_mov_b32 v106, 0
    v_mov_b32 v107, 0
    v_mov_b32 v108, 0
    v_mov_b32 v109, 0
    v_mov_b32 v110, 0
    v_mov_b32 v111, 0
    v_mov_b32 v112, 0
    v_mov_b32 v113, 0
    v_mov_b32 v114, 0
    v_mov_b32 v115, 0
    v_mov_b32 v116, 0
    v_mov_b32 v117, 0
    v_mov_b32 v118, 0
    v_mov_b32 v119, 0
    v_mov_b32 v120, 0
    v_mov_b32 v121, 0
    v_mov_b32 v122, 0
    v_mov_b32 v123, 0
    v_mov_b32 v124, 0
    v_mov_b32 v125, 0
    v_mov_b32 v126, 0
    v_mov_b32 v127, 0
    s_mov_b32 s38, 0
    s_mov_b32 s39, 0
    s_mov_b32 s40, 0
    s_cmp_eq_u32 s43, 1
    s_cbranch_scc1 K1_LOOP_F
    buffer_load_dwordx4 v[24:27], v4, s[4:7], s38 offen
    buffer_load_dwordx4 v[28:31], v5, s[4:7], s38 offen
    buffer_load_dwordx4 v[32:35], v6, s[4:7], s38 offen
    buffer_load_dwordx4 v[36:39], v7, s[4:7], s38 offen
    buffer_load_dwordx4 v[40:43], v8, s[8:11], s39 offen
    buffer_load_dwordx4 v[44:47], v8, s[12:15], s39 offen
    buffer_load_dwordx4 v[48:51], v10, s[8:11], s39 offen
    buffer_load_dwordx4 v[52:55], v10, s[12:15], s39 offen
    s_waitcnt vmcnt(0)
    ds_write_b128 v12, v[24:27] offset:0
    ds_write_b128 v12, v[28:31] offset:4608
    ds_write_b128 v12, v[32:35] offset:9216
    ds_write_b128 v12, v[36:39] offset:13824
    ds_write_b128 v56, v[40:43] offset:0
    ds_write_b128 v56, v[44:47] offset:4608
    ds_write_b128 v56, v[48:51] offset:9216
    ds_write_b128 v56, v[52:55] offset:13824
    s_add_u32 s38, s38, 128
    s_add_u32 s39, s39, s42
    s_waitcnt lgkmcnt(0)
    s_barrier
K1_LS:
    buffer_load_dwordx4 v[24:27], v4, s[4:7], s38 offen
    buffer_load_dwordx4 v[28:31], v5, s[4:7], s38 offen
    buffer_load_dwordx4 v[32:35], v6, s[4:7], s38 offen
    buffer_load_dwordx4 v[36:39], v7, s[4:7], s38 offen
    buffer_load_dwordx4 v[40:43], v8, s[8:11], s39 offen
    buffer_load_dwordx4 v[44:47], v8, s[12:15], s39 offen
    buffer_load_dwordx4 v[48:51], v10, s[8:11], s39 offen
    buffer_load_dwordx4 v[52:55], v10, s[12:15], s39 offen
    ds_read_b128 v[128:131], v17 offset:0
    ds_read_b128 v[132:135], v17 offset:2304
    ds_read_b128 v[136:139], v18 offset:0
    ds_read_b128 v[140:143], v18 offset:4608
    s_waitcnt lgkmcnt(0)
    v_mfma_f32_32x32x16_bf16 v[64:79], v[128:131], v[136:139], v[64:79]
    v_mfma_f32_32x32x16_bf16 v[80:95], v[128:131], v[140:143], v[80:95]
    v_mfma_f32_32x32x16_bf16 v[96:111], v[132:135], v[136:139], v[96:111]
    v_mfma_f32_32x32x16_bf16 v[112:127], v[132:135], v[140:143], v[112:127]
    ds_read_b128 v[128:131], v17 offset:32
    ds_read_b128 v[132:135], v17 offset:2336
    ds_read_b128 v[136:139], v18 offset:32
    ds_read_b128 v[140:143], v18 offset:4640
    s_waitcnt lgkmcnt(0)
    v_mfma_f32_32x32x16_bf16 v[64:79], v[128:131], v[136:139], v[64:79]
    v_mfma_f32_32x32x16_bf16 v[80:95], v[128:131], v[140:143], v[80:95]
    v_mfma_f32_32x32x16_bf16 v[96:111], v[132:135], v[136:139], v[96:111]
    v_mfma_f32_32x32x16_bf16 v[112:127], v[132:135], v[140:143], v[112:127]
    ds_read_b128 v[128:131], v17 offset:64
    ds_read_b128 v[132:135], v17 offset:2368
    ds_read_b128 v[136:139], v18 offset:64
    ds_read_b128 v[140:143], v18 offset:4672
    s_waitcnt lgkmcnt(0)
    v_mfma_f32_32x32x16_bf16 v[64:79], v[128:131], v[136:139], v[64:79]
    v_mfma_f32_32x32x16_bf16 v[80:95], v[128:131], v[140:143], v[80:95]
    v_mfma_f32_32x32x16_bf16 v[96:111], v[132:135], v[136:139], v[96:111]
    v_mfma_f32_32x32x16_bf16 v[112:127], v[132:135], v[140:143], v[112:127]
    ds_read_b128 v[128:131], v17 offset:96
    ds_read_b128 v[132:135], v17 offset:2400
    ds_read_b128 v[136:139], v18 offset:96
    ds_read_b128 v[140:143], v18 offset:4704
    s_waitcnt lgkmcnt(0)
    v_mfma_f32_32x32x16_bf16 v[64:79], v[128:131], v[136:139], v[64:79]
    v_mfma_f32_32x32x16_bf16 v[80:95], v[128:131], v[140:143], v[80:95]
    v_mfma_f32_32x32x16_bf16 v[96:111], v[132:135], v[136:139], v[96:111]
    v_mfma_f32_32x32x16_bf16 v[112:127], v[132:135], v[140:143], v[112:127]
    s_waitcnt vmcnt(0)
    ds_write_b128 v12, v[24:27] offset:38912
    ds_write_b128 v12, v[28:31] offset:43520
    ds_write_b128 v12, v[32:35] offset:48128
    ds_write_b128 v12, v[36:39] offset:52736
    ds_write_b128 v56, v[40:43] offset:38912
    ds_write_b128 v56, v[44:47] offset:43520
    ds_write_b128 v56, v[48:51] offset:48128
    ds_write_b128 v56, v[52:55] offset:52736
    s_add_u32 s38, s38, 128
    s_add_u32 s39, s39, s42
    s_waitcnt lgkmcnt(0)
    s_barrier
    buffer_load_dwordx4 v[24:27], v4, s[4:7], s38 offen
    buffer_load_dwordx4 v[28:31], v5, s[4:7], s38 offen
    buffer_load_dwordx4 v[32:35], v6, s[4:7], s38 offen
    buffer_load_dwordx4 v[36:39], v7, s[4:7], s38 offen
    buffer_load_dwordx4 v[40:43], v8, s[8:11], s39 offen
    buffer_load_dwordx4 v[44:47], v8, s[12:15], s39 offen
    buffer_load_dwordx4 v[48:51], v10, s[8:11], s39 offen
    buffer_load_dwordx4 v[52:55], v10, s[12:15], s39 offen
    ds_read_b128 v[128:131], v17 offset:38912
    ds_read_b128 v[132:135], v17 offset:41216
    ds_read_b128 v[136:139], v18 offset:38912
    ds_read_b128 v[140:143], v18 offset:43520
    s_waitcnt lgkmcnt(0)
    v_mfma_f32_32x32x16_bf16 v[64:79], v[128:131], v[136:139], v[64:79]
    v_mfma_f32_32x32x16_bf16 v[80:95], v[128:131], v[140:143], v[80:95]
    v_mfma_f32_32x32x16_bf16 v[96:111], v[132:135], v[136:139], v[96:111]
    v_mfma_f32_32x32x16_bf16 v[112:127], v[132:135], v[140:143], v[112:127]
    ds_read_b128 v[128:131], v17 offset:38944
    ds_read_b128 v[132:135], v17 offset:41248
    ds_read_b128 v[136:139], v18 offset:38944
    ds_read_b128 v[140:143], v18 offset:43552
    s_waitcnt lgkmcnt(0)
    v_mfma_f32_32x32x16_bf16 v[64:79], v[128:131], v[136:139], v[64:79]
    v_mfma_f32_32x32x16_bf16 v[80:95], v[128:131], v[140:143], v[80:95]
    v_mfma_f32_32x32x16_bf16 v[96:111], v[132:135], v[136:139], v[96:111]
    v_mfma_f32_32x32x16_bf16 v[112:127], v[132:135], v[140:143], v[112:127]
    ds_read_b128 v[128:131], v17 offset:38976
    ds_read_b128 v[132:135], v17 offset:41280
    ds_read_b128 v[136:139], v18 offset:38976
    ds_read_b128 v[140:143], v18 offset:43584
    s_waitcnt lgkmcnt(0)
    v_mfma_f32_32x32x16_bf16 v[64:79], v[128:131], v[136:139], v[64:79]
    v_mfma_f32_32x32x16_bf16 v[80:95], v[128:131], v[140:143], v[80:95]
    v_mfma_f32_32x32x16_bf16 v[96:111], v[132:135], v[136:139], v[96:111]
    v_mfma_f32_32x32x16_bf16 v[112:127], v[132:135], v[140:143], v[112:127]
    ds_read_b128 v[128:131], v17 offset:39008
    ds_read_b128 v[132:135], v17 offset:41312
    ds_read_b128 v[136:139], v18 offset:39008
    ds_read_b128 v[140:143], v18 offset:43616
    s_waitcnt lgkmcnt(0)
    v_mfma_f32_32x32x16_bf16 v[64:79], v[128:131], v[136:139], v[64:79]
    v_mfma_f32_32x32x16_bf16 v[80:95], v[128:131], v[140:143], v[80:95]
    v_mfma_f32_32x32x16_bf16 v[96:111], v[132:135], v[136:139], v[96:111]
    v_mfma_f32_32x32x16_bf16 v[112:127], v[132:135], v[140:143], v[112:127]
    s_waitcnt vmcnt(0)
    ds_write_b128 v12, v[24:27] offset:0
    ds_write_b128 v12, v[28:31] offset:4608
    ds_write_b128 v12, v[32:35] offset:9216
    ds_write_b128 v12, v[36:39] offset:13824
    ds_write_b128 v56, v[40:43] offset:0
    ds_write_b128 v56, v[44:47] offset:4608
    ds_write_b128 v56, v[48:51] offset:9216
    ds_write_b128 v56, v[52:55] offset:13824
    s_add_u32 s38, s38, 128
    s_add_u32 s39, s39, s42
    s_waitcnt lgkmcnt(0)
    s_barrier
    s_add_u32 s40, s40, 2
    s_cmp_lt_u32 s40, 10
    s_cbranch_scc1 K1_LS
    s_nop 15
    s_branch K1_EPI_S
K1_LOOP_F:
    buffer_load_dwordx4 v[24:27], v4, s[4:7], s38 offen
    buffer_load_dwordx4 v[28:31], v5, s[4:7], s38 offen
    buffer_load_dwordx4 v[32:35], v6, s[4:7], s38 offen
    buffer_load_dwordx4 v[36:39], v7, s[4:7], s38 offen
    buffer_load_dwordx4 v[40:43], v8, s[8:11], s39 offen
    buffer_load_dwordx4 v[44:47], v9, s[8:11], s39 offen
    buffer_load_dwordx4 v[48:51], v10, s[8:11], s39 offen
    buffer_load_dwordx4 v[52:55], v11, s[8:11], s39 offen
    s_waitcnt vmcnt(0)
    ds_write_b128 v12, v[24:27] offset:0
    ds_write_b128 v12, v[28:31] offset:4608
    ds_write_b128 v12, v[32:35] offset:9216
    ds_write_b128 v12, v[36:39] offset:13824
    ds_write_b128 v13, v[40:43] offset:0
    ds_write_b128 v13, v[44:47] offset:5120
    ds_write_b128 v13, v[48:51] offset:10240
    ds_write_b128 v13, v[52:55] offset:15360
    s_add_u32 s38, s38, 128
    s_add_u32 s39, s39, s42
    s_waitcnt lgkmcnt(0)
    s_barrier
K1_LF:
    buffer_load_dwordx4 v[24:27], v4, s[4:7], s38 offen
    buffer_load_dwordx4 v[28:31], v5, s[4:7], s38 offen
    buffer_load_dwordx4 v[32:35], v6, s[4:7], s38 offen
    buffer_load_dwordx4 v[36:39], v7, s[4:7], s38 offen
    buffer_load_dwordx4 v[40:43], v8, s[8:11], s39 offen
    buffer_load_dwordx4 v[44:47], v9, s[8:11], s39 offen
    buffer_load_dwordx4 v[48:51], v10, s[8:11], s39 offen
    buffer_load_dwordx4 v[52:55], v11, s[8:11], s39 offen
    ds_read_b128 v[128:131], v17 offset:0
    ds_read_b128 v[132:135], v17 offset:4608
    ds_read_b64_tr_b16 v[136:137], v19 offset:0
    ds_read_b64_tr_b16 v[138:139], v19 offset:1280
    ds_read_b64_tr_b16 v[140:141], v19 offset:64
    ds_read_b64_tr_b16 v[142:143], v19 offset:1344
    s_waitcnt lgkmcnt(0)
    v_mfma_f32_32x32x16_bf16 v[64:79], v[136:139], v[128:131], v[64:79]
    v_mfma_f32_32x32x16_bf16 v[80:95], v[140:143], v[128:131], v[80:95]
    v_mfma_f32_32x32x16_bf16 v[96:111], v[136:139], v[132:135], v[96:111]
    v_mfma_f32_32x32x16_bf16 v[112:127], v[140:143], v[132:135], v[112:127]
    ds_read_b128 v[128:131], v17 offset:32
    ds_read_b128 v[132:135], v17 offset:4640
    ds_read_b64_tr_b16 v[136:137], v19 offset:5120
    ds_read_b64_tr_b16 v[138:139], v19 offset:6400
    ds_read_b64_tr_b16 v[140:141], v19 offset:5184
    ds_read_b64_tr_b16 v[142:143], v19 offset:6464
    s_waitcnt lgkmcnt(0)
    v_mfma_f32_32x32x16_bf16 v[64:79], v[136:139], v[128:131], v[64:79]
    v_mfma_f32_32x32x16_bf16 v[80:95], v[140:143], v[128:131], v[80:95]
    v_mfma_f32_32x32x16_bf16 v[96:111], v[136:139], v[132:135], v[96:111]
    v_mfma_f32_32x32x16_bf16 v[112:127], v[140:143], v[132:135], v[112:127]
    ds_read_b128 v[128:131], v17 offset:64
    ds_read_b128 v[132:135], v17 offset:4672
    ds_read_b64_tr_b16 v[136:137], v19 offset:10240
    ds_read_b64_tr_b16 v[138:139], v19 offset:11520
    ds_read_b64_tr_b16 v[140:141], v19 offset:10304
    ds_read_b64_tr_b16 v[142:143], v19 offset:11584
    s_waitcnt lgkmcnt(0)
    v_mfma_f32_32x32x16_bf16 v[64:79], v[136:139], v[128:131], v[64:79]
    v_mfma_f32_32x32x16_bf16 v[80:95], v[140:143], v[128:131], v[80:95]
    v_mfma_f32_32x32x16_bf16 v[96:111], v[136:139], v[132:135], v[96:111]
    v_mfma_f32_32x32x16_bf16 v[112:127], v[140:143], v[132:135], v[112:127]
    ds_read_b128 v[128:131], v17 offset:96
    ds_read_b128 v[132:135], v17 offset:4704
    ds_read_b64_tr_b16 v[136:137], v19 offset:15360
    ds_read_b64_tr_b16 v[138:139], v19 offset:16640
    ds_read_b64_tr_b16 v[140:141], v19 offset:15424
    ds_read_b64_tr_b16 v[142:143], v19 offset:16704
    s_waitcnt lgkmcnt(0)
    v_mfma_f32_32x32x16_bf16 v[64:79], v[136:139], v[128:131], v[64:79]
    v_mfma_f32_32x32x16_bf16 v[80:95], v[140:143], v[128:131], v[80:95]
    v_mfma_f32_32x32x16_bf16 v[96:111], v[136:139], v[132:135], v[96:111]
    v_mfma_f32_32x32x16_bf16 v[112:127], v[140:143], v[132:135], v[112:127]
    s_waitcnt vmcnt(0)
    ds_write_b128 v12, v[24:27] offset:38912
    ds_write_b128 v12, v[28:31] offset:43520
    ds_write_b128 v12, v[32:35] offset:48128
    ds_write_b128 v12, v[36:39] offset:52736
    ds_write_b128 v13, v[40:43] offset:38912
    ds_write_b128 v13, v[44:47] offset:44032
    ds_write_b128 v13, v[48:51] offset:49152
    ds_write_b128 v13, v[52:55] offset:54272
    s_add_u32 s38, s38, 128
    s_add_u32 s39, s39, s42
    s_waitcnt lgkmcnt(0)
    s_barrier
    buffer_load_dwordx4 v[24:27], v4, s[4:7], s38 offen
    buffer_load_dwordx4 v[28:31], v5, s[4:7], s38 offen
    buffer_load_dwordx4 v[32:35], v6, s[4:7], s38 offen
    buffer_load_dwordx4 v[36:39], v7, s[4:7], s38 offen
    buffer_load_dwordx4 v[40:43], v8, s[8:11], s39 offen
    buffer_load_dwordx4 v[44:47], v9, s[8:11], s39 offen
    buffer_load_dwordx4 v[48:51], v10, s[8:11], s39 offen
    buffer_load_dwordx4 v[52:55], v11, s[8:11], s39 offen
    ds_read_b128 v[128:131], v17 offset:38912
    ds_read_b128 v[132:135], v17 offset:43520
    ds_read_b64_tr_b16 v[136:137], v19 offset:38912
    ds_read_b64_tr_b16 v[138:139], v19 offset:40192
    ds_read_b64_tr_b16 v[140:141], v19 offset:38976
    ds_read_b64_tr_b16 v[142:143], v19 offset:40256
    s_waitcnt lgkmcnt(0)
    v_mfma_f32_32x32x16_bf16 v[64:79], v[136:139], v[128:131], v[64:79]
    v_mfma_f32_32x32x16_bf16 v[80:95], v[140:143], v[128:131], v[80:95]
    v_mfma_f32_32x32x16_bf16 v[96:111], v[136:139], v[132:135], v[96:111]
    v_mfma_f32_32x32x16_bf16 v[112:127], v[140:143], v[132:135], v[112:127]
    ds_read_b128 v[128:131], v17 offset:38944
    ds_read_b128 v[132:135], v17 offset:43552
    ds_read_b64_tr_b16 v[136:137], v19 offset:44032
    ds_read_b64_tr_b16 v[138:139], v19 offset:45312
    ds_read_b64_tr_b16 v[140:141], v19 offset:44096
    ds_read_b64_tr_b16 v[142:143], v19 offset:45376
    s_waitcnt lgkmcnt(0)
    v_mfma_f32_32x32x16_bf16 v[64:79], v[136:139], v[128:131], v[64:79]
    v_mfma_f32_32x32x16_bf16 v[80:95], v[140:143], v[128:131], v[80:95]
    v_mfma_f32_32x32x16_bf16 v[96:111], v[136:139], v[132:135], v[96:111]
    v_mfma_f32_32x32x16_bf16 v[112:127], v[140:143], v[132:135], v[112:127]
    ds_read_b128 v[128:131], v17 offset:38976
    ds_read_b128 v[132:135], v17 offset:43584
    ds_read_b64_tr_b16 v[136:137], v19 offset:49152
    ds_read_b64_tr_b16 v[138:139], v19 offset:50432
    ds_read_b64_tr_b16 v[140:141], v19 offset:49216
    ds_read_b64_tr_b16 v[142:143], v19 offset:50496
    s_waitcnt lgkmcnt(0)
    v_mfma_f32_32x32x16_bf16 v[64:79], v[136:139], v[128:131], v[64:79]
    v_mfma_f32_32x32x16_bf16 v[80:95], v[140:143], v[128:131], v[80:95]
    v_mfma_f32_32x32x16_bf16 v[96:111], v[136:139], v[132:135], v[96:111]
    v_mfma_f32_32x32x16_bf16 v[112:127], v[140:143], v[132:135], v[112:127]
    ds_read_b128 v[128:131], v17 offset:39008
    ds_read_b128 v[132:135], v17 offset:43616
    ds_read_b64_tr_b16 v[136:137], v19 offset:54272
    ds_read_b64_tr_b16 v[138:139], v19 offset:55552
    ds_read_b64_tr_b16 v[140:141], v19 offset:54336
    ds_read_b64_tr_b16 v[142:143], v19 offset:55616
    s_waitcnt lgkmcnt(0)
    v_mfma_f32_32x32x16_bf16 v[64:79], v[136:139], v[128:131], v[64:79]
    v_mfma_f32_32x32x16_bf16 v[80:95], v[140:143], v[128:131], v[80:95]
    v_mfma_f32_32x32x16_bf16 v[96:111], v[136:139], v[132:135], v[96:111]
    v_mfma_f32_32x32x16_bf16 v[112:127], v[140:143], v[132:135], v[112:127]
    s_waitcnt vmcnt(0)
    ds_write_b128 v12, v[24:27] offset:0
    ds_write_b128 v12, v[28:31] offset:4608
    ds_write_b128 v12, v[32:35] offset:9216
    ds_write_b128 v12, v[36:39] offset:13824
    ds_write_b128 v13, v[40:43] offset:0
    ds_write_b128 v13, v[44:47] offset:5120
    ds_write_b128 v13, v[48:51] offset:10240
    ds_write_b128 v13, v[52:55] offset:15360
    s_add_u32 s38, s38, 128
    s_add_u32 s39, s39, s42
    s_waitcnt lgkmcnt(0)
    s_barrier
    s_add_u32 s40, s40, 2
    s_cmp_lt_u32 s40, 10
    s_cbranch_scc1 K1_LF
    s_nop 15
    s_cmp_eq_u32 s37, 13
    s_cselect_b32 s41, 1, 0
    v_mov_b32 v20, s41
    v_and_b32 v20, v20, v15
    v_cmp_eq_u32 vcc, 0, v20
    s_and_saveexec_b64 s[66:67], vcc
    s_cbranch_execz K1_END
    s_lshl_b32 s41, s36, 7
    v_lshl_add_u32 v20, v14, 6, v16
    v_add_u32 v20, s41, v20
    v_mul_u32_u24 v20, 3456, v20
    s_lshl_b32 s41, s37, 8
    v_lshrrev_b32 v21, 5, v2
    v_lshlrev_b32 v21, 3, v21
    v_lshl_add_u32 v21, v15, 7, v21
    v_add3_u32 v20, v20, v21, s41
    v_add_u32 v21, 110592, v20
    v_max_f32 v64, 0, v64
    v_max_f32 v65, 0, v65
    v_max_f32 v66, 0, v66
    v_max_f32 v67, 0, v67
    v_cvt_pk_bf16_f32 v22, v64, v65
    v_cvt_pk_bf16_f32 v23, v66, v67
    buffer_store_dwordx2 v[22:23], v20, s[16:19], 0 offen offset:0
    s_nop 1
    v_max_f32 v68, 0, v68
    v_max_f32 v69, 0, v69
    v_max_f32 v70, 0, v70
    v_max_f32 v71, 0, v71
    v_cvt_pk_bf16_f32 v22, v68, v69
    v_cvt_pk_bf16_f32 v23, v70, v71
    buffer_store_dwordx2 v[22:23], v20, s[16:19], 0 offen offset:16
    s_nop 1
    v_max_f32 v72, 0, v72
    v_max_f32 v73, 0, v73
    v_max_f32 v74, 0, v74
    v_max_f32 v75, 0, v75
    v_cvt_pk_bf16_f32 v22, v72, v73
    v_cvt_pk_bf16_f32 v23, v74, v75
    buffer_store_dwordx2 v[22:23], v20, s[16:19], 0 offen offset:32
    s_nop 1
    v_max_f32 v76, 0, v76
    v_max_f32 v77, 0, v77
    v_max_f32 v78, 0, v78
    v_max_f32 v79, 0, v79
    v_cvt_pk_bf16_f32 v22, v76, v77
    v_cvt_pk_bf16_f32 v23, v78, v79
    buffer_store_dwordx2 v[22:23], v20, s[16:19], 0 offen offset:48
    s_nop 1
    v_max_f32 v80, 0, v80
    v_max_f32 v81, 0, v81
    v_max_f32 v82, 0, v82
    v_max_f32 v83, 0, v83
    v_cvt_pk_bf16_f32 v22, v80, v81
    v_cvt_pk_bf16_f32 v23, v82, v83
    buffer_store_dwordx2 v[22:23], v20, s[16:19], 0 offen offset:64
    s_nop 1
    v_max_f32 v84, 0, v84
    v_max_f32 v85, 0, v85
    v_max_f32 v86, 0, v86
    v_max_f32 v87, 0, v87
    v_cvt_pk_bf16_f32 v22, v84, v85
    v_cvt_pk_bf16_f32 v23, v86, v87
    buffer_store_dwordx2 v[22:23], v20, s[16:19], 0 offen offset:80
    s_nop 1
    v_max_f32 v88, 0, v88
    v_max_f32 v89, 0, v89
    v_max_f32 v90, 0, v90
    v_max_f32 v91, 0, v91
    v_cvt_pk_bf16_f32 v22, v88, v89
    v_cvt_pk_bf16_f32 v23, v90, v91
    buffer_store_dwordx2 v[22:23], v20, s[16:19], 0 offen offset:96
    s_nop 1
    v_max_f32 v92, 0, v92
    v_max_f32 v93, 0, v93
    v_max_f32 v94, 0, v94
    v_max_f32 v95, 0, v95
    v_cvt_pk_bf16_f32 v22, v92, v93
    v_cvt_pk_bf16_f32 v23, v94, v95
    buffer_store_dwordx2 v[22:23], v20, s[16:19], 0 offen offset:112
    s_nop 1
    v_max_f32 v96, 0, v96
    v_max_f32 v97, 0, v97
    v_max_f32 v98, 0, v98
    v_max_f32 v99, 0, v99
    v_cvt_pk_bf16_f32 v22, v96, v97
    v_cvt_pk_bf16_f32 v23, v98, v99
    buffer_store_dwordx2 v[22:23], v21, s[16:19], 0 offen offset:0
    s_nop 1
    v_max_f32 v100, 0, v100
    v_max_f32 v101, 0, v101
    v_max_f32 v102, 0, v102
    v_max_f32 v103, 0, v103
    v_cvt_pk_bf16_f32 v22, v100, v101
    v_cvt_pk_bf16_f32 v23, v102, v103
    buffer_store_dwordx2 v[22:23], v21, s[16:19], 0 offen offset:16
    s_nop 1
    v_max_f32 v104, 0, v104
    v_max_f32 v105, 0, v105
    v_max_f32 v106, 0, v106
    v_max_f32 v107, 0, v107
    v_cvt_pk_bf16_f32 v22, v104, v105
    v_cvt_pk_bf16_f32 v23, v106, v107
    buffer_store_dwordx2 v[22:23], v21, s[16:19], 0 offen offset:32
    s_nop 1
    v_max_f32 v108, 0, v108
    v_max_f32 v109, 0, v109
    v_max_f32 v110, 0, v110
    v_max_f32 v111, 0, v111
    v_cvt_pk_bf16_f32 v22, v108, v109
    v_cvt_pk_bf16_f32 v23, v110, v111
    buffer_store_dwordx2 v[22:23], v21, s[16:19], 0 offen offset:48
    s_nop 1
    v_max_f32 v112, 0, v112
    v_max_f32 v113, 0, v113
    v_max_f32 v114, 0, v114
    v_max_f32 v115, 0, v115
    v_cvt_pk_bf16_f32 v22, v112, v113
    v_cvt_pk_bf16_f32 v23, v114, v115
    buffer_store_dwordx2 v[22:23], v21, s[16:19], 0 offen offset:64
    s_nop 1
    v_max_f32 v116, 0, v116
    v_max_f32 v117, 0, v117
    v_max_f32 v118, 0, v118
    v_max_f32 v119, 0, v119
    v_cvt_pk_bf16_f32 v22, v116, v117
    v_cvt_pk_bf16_f32 v23, v118, v119
    buffer_store_dwordx2 v[22:23], v21, s[16:19], 0 offen offset:80
    s_nop 1
    v_max_f32 v120, 0, v120
    v_max_f32 v121, 0, v121
    v_max_f32 v122, 0, v122
    v_max_f32 v123, 0, v123
    v_cvt_pk_bf16_f32 v22, v120, v121
    v_cvt_pk_bf16_f32 v23, v122, v123
    buffer_store_dwordx2 v[22:23], v21, s[16:19], 0 offen offset:96
    s_nop 1
    v_max_f32 v124, 0, v124
    v_max_f32 v125, 0, v125
    v_max_f32 v126, 0, v126
    v_max_f32 v127, 0, v127
    v_cvt_pk_bf16_f32 v22, v124, v125
    v_cvt_pk_bf16_f32 v23, v126, v127
    buffer_store_dwordx2 v[22:23], v21, s[16:19], 0 offen offset:112
    s_nop 1
    s_branch K1_END
K1_EPI_S:
    s_lshl_b32 s41, s37, 6
    v_lshl_add_u32 v20, v15, 5, v16
    v_add_u32 v20, s41, v20
    v_lshlrev_b32 v132, 1, v20
    buffer_load_ushort v133, v132, s[24:27], 0 offen
    buffer_load_ushort v134, v132, s[28:31], 0 offen
    buffer_load_ushort v135, v132, s[32:35], 0 offen
    s_waitcnt vmcnt(0)
    v_lshlrev_b32 v133, 16, v133
    v_lshlrev_b32 v134, 16, v134
    v_lshlrev_b32 v135, 16, v135
    v_mul_f32 v135, 0x3fb8aa3b, v135
    v_exp_f32 v135, v135
    s_nop 1
    v_cvt_pk_bf16_f32 v135, v135, v135
    v_lshlrev_b32 v135, 16, v135
    v_mul_f32 v136, v135, v133
    v_mul_f32 v137, v135, v134
    v_mul_f32 v136, 0x3fb8aa3b, v136
    v_exp_f32 v136, v136
    v_mul_f32 v137, 0.15915494, v137
    v_cos_f32 v128, v137
    v_sin_f32 v129, v137
    s_nop 1
    v_mul_f32 v128, v128, v136
    v_mul_f32 v129, v129, v136
    v_add_f32 v136, -1.0, v128
    v_mul_f32 v137, v133, v133
    v_fma_f32 v137, v134, v134, v137
    v_rcp_f32 v137, v137
    v_mul_f32 v138, v136, v133
    v_fma_f32 v138, v129, v134, v138
    v_mul_f32 v139, v129, v133
    v_fma_f32 v139, -v136, v134, v139
    v_mul_f32 v130, v138, v137
    v_mul_f32 v131, v139, v137
    s_lshl_b32 s41, s36, 7
    v_lshrrev_b32 v21, 5, v2
    v_lshlrev_b32 v21, 5, v21
    v_lshl_add_u32 v21, v14, 6, v21
    v_add_u32 v21, s41, v21
    v_mul_u32_u24 v22, 640, v21
    v_add_u32 v22, v22, v20
    v_lshlrev_b32 v22, 2, v22
    v_mov_b32 v140, 0
    v_mov_b32 v141, 0
    s_mov_b32 s41, 0
    v_mul_f32 v142, v130, v64
    v_fma_f32 v142, -v131, v80, v142
    v_mul_f32 v143, v130, v80
    v_fma_f32 v143, v131, v64, v143
    v_fma_f32 v142, v128, v140, v142
    v_fma_f32 v143, v128, v141, v143
    v_fma_f32 v142, -v129, v141, v142
    v_fma_f32 v143, v129, v140, v143
    v_mov_b32 v140, v142
    v_mov_b32 v141, v143
    v_cvt_pk_bf16_f32 v144, v140, v141
    buffer_store_dword v144, v22, s[16:19], s41 offen
    s_add_u32 s41, s41, 2560
    v_mul_f32 v142, v130, v65
    v_fma_f32 v142, -v131, v81, v142
    v_mul_f32 v143, v130, v81
    v_fma_f32 v143, v131, v65, v143
    v_fma_f32 v142, v128, v140, v142
    v_fma_f32 v143, v128, v141, v143
    v_fma_f32 v142, -v129, v141, v142
    v_fma_f32 v143, v129, v140, v143
    v_mov_b32 v140, v142
    v_mov_b32 v141, v143
    v_cvt_pk_bf16_f32 v144, v140, v141
    buffer_store_dword v144, v22, s[16:19], s41 offen
    s_add_u32 s41, s41, 2560
    v_mul_f32 v142, v130, v66
    v_fma_f32 v142, -v131, v82, v142
    v_mul_f32 v143, v130, v82
    v_fma_f32 v143, v131, v66, v143
    v_fma_f32 v142, v128, v140, v142
    v_fma_f32 v143, v128, v141, v143
    v_fma_f32 v142, -v129, v141, v142
    v_fma_f32 v143, v129, v140, v143
    v_mov_b32 v140, v142
    v_mov_b32 v141, v143
    v_cvt_pk_bf16_f32 v144, v140, v141
    buffer_store_dword v144, v22, s[16:19], s41 offen
    s_add_u32 s41, s41, 2560
    v_mul_f32 v142, v130, v67
    v_fma_f32 v142, -v131, v83, v142
    v_mul_f32 v143, v130, v83
    v_fma_f32 v143, v131, v67, v143
    v_fma_f32 v142, v128, v140, v142
    v_fma_f32 v143, v128, v141, v143
    v_fma_f32 v142, -v129, v141, v142
    v_fma_f32 v143, v129, v140, v143
    v_mov_b32 v140, v142
    v_mov_b32 v141, v143
    v_cvt_pk_bf16_f32 v144, v140, v141
    buffer_store_dword v144, v22, s[16:19], s41 offen
    s_add_u32 s41, s41, 2560
    v_mul_f32 v142, v130, v68
    v_fma_f32 v142, -v131, v84, v142
    v_mul_f32 v143, v130, v84
    v_fma_f32 v143, v131, v68, v143
    v_fma_f32 v142, v128, v140, v142
    v_fma_f32 v143, v128, v141, v143
    v_fma_f32 v142, -v129, v141, v142
    v_fma_f32 v143, v129, v140, v143
    v_mov_b32 v140, v142
    v_mov_b32 v141, v143
    v_cvt_pk_bf16_f32 v144, v140, v141
    buffer_store_dword v144, v22, s[16:19], s41 offen
    s_add_u32 s41, s41, 2560
    v_mul_f32 v142, v130, v69
    v_fma_f32 v142, -v131, v85, v142
    v_mul_f32 v143, v130, v85
    v_fma_f32 v143, v131, v69, v143
    v_fma_f32 v142, v128, v140, v142
    v_fma_f32 v143, v128, v141, v143
    v_fma_f32 v142, -v129, v141, v142
    v_fma_f32 v143, v129, v140, v143
    v_mov_b32 v140, v142
    v_mov_b32 v141, v143
    v_cvt_pk_bf16_f32 v144, v140, v141
    buffer_store_dword v144, v22, s[16:19], s41 offen
    s_add_u32 s41, s41, 2560
    v_mul_f32 v142, v130, v70
    v_fma_f32 v142, -v131, v86, v142
    v_mul_f32 v143, v130, v86
    v_fma_f32 v143, v131, v70, v143
    v_fma_f32 v142, v128, v140, v142
    v_fma_f32 v143, v128, v141, v143
    v_fma_f32 v142, -v129, v141, v142
    v_fma_f32 v143, v129, v140, v143
    v_mov_b32 v140, v142
    v_mov_b32 v141, v143
    v_cvt_pk_bf16_f32 v144, v140, v141
    buffer_store_dword v144, v22, s[16:19], s41 offen
    s_add_u32 s41, s41, 2560
    v_mul_f32 v142, v130, v71
    v_fma_f32 v142, -v131, v87, v142
    v_mul_f32 v143, v130, v87
    v_fma_f32 v143, v131, v71, v143
    v_fma_f32 v142, v128, v140, v142
    v_fma_f32 v143, v128, v141, v143
    v_fma_f32 v142, -v129, v141, v142
    v_fma_f32 v143, v129, v140, v143
    v_mov_b32 v140, v142
    v_mov_b32 v141, v143
    v_cvt_pk_bf16_f32 v144, v140, v141
    buffer_store_dword v144, v22, s[16:19], s41 offen
    s_add_u32 s41, s41, 2560
    v_mul_f32 v142, v130, v72
    v_fma_f32 v142, -v131, v88, v142
    v_mul_f32 v143, v130, v88
    v_fma_f32 v143, v131, v72, v143
    v_fma_f32 v142, v128, v140, v142
    v_fma_f32 v143, v128, v141, v143
    v_fma_f32 v142, -v129, v141, v142
    v_fma_f32 v143, v129, v140, v143
    v_mov_b32 v140, v142
    v_mov_b32 v141, v143
    v_cvt_pk_bf16_f32 v144, v140, v141
    buffer_store_dword v144, v22, s[16:19], s41 offen
    s_add_u32 s41, s41, 2560
    v_mul_f32 v142, v130, v73
    v_fma_f32 v142, -v131, v89, v142
    v_mul_f32 v143, v130, v89
    v_fma_f32 v143, v131, v73, v143
    v_fma_f32 v142, v128, v140, v142
    v_fma_f32 v143, v128, v141, v143
    v_fma_f32 v142, -v129, v141, v142
    v_fma_f32 v143, v129, v140, v143
    v_mov_b32 v140, v142
    v_mov_b32 v141, v143
    v_cvt_pk_bf16_f32 v144, v140, v141
    buffer_store_dword v144, v22, s[16:19], s41 offen
    s_add_u32 s41, s41, 2560
    v_mul_f32 v142, v130, v74
    v_fma_f32 v142, -v131, v90, v142
    v_mul_f32 v143, v130, v90
    v_fma_f32 v143, v131, v74, v143
    v_fma_f32 v142, v128, v140, v142
    v_fma_f32 v143, v128, v141, v143
    v_fma_f32 v142, -v129, v141, v142
    v_fma_f32 v143, v129, v140, v143
    v_mov_b32 v140, v142
    v_mov_b32 v141, v143
    v_cvt_pk_bf16_f32 v144, v140, v141
    buffer_store_dword v144, v22, s[16:19], s41 offen
    s_add_u32 s41, s41, 2560
    v_mul_f32 v142, v130, v75
    v_fma_f32 v142, -v131, v91, v142
    v_mul_f32 v143, v130, v91
    v_fma_f32 v143, v131, v75, v143
    v_fma_f32 v142, v128, v140, v142
    v_fma_f32 v143, v128, v141, v143
    v_fma_f32 v142, -v129, v141, v142
    v_fma_f32 v143, v129, v140, v143
    v_mov_b32 v140, v142
    v_mov_b32 v141, v143
    v_cvt_pk_bf16_f32 v144, v140, v141
    buffer_store_dword v144, v22, s[16:19], s41 offen
    s_add_u32 s41, s41, 2560
    v_mul_f32 v142, v130, v76
    v_fma_f32 v142, -v131, v92, v142
    v_mul_f32 v143, v130, v92
    v_fma_f32 v143, v131, v76, v143
    v_fma_f32 v142, v128, v140, v142
    v_fma_f32 v143, v128, v141, v143
    v_fma_f32 v142, -v129, v141, v142
    v_fma_f32 v143, v129, v140, v143
    v_mov_b32 v140, v142
    v_mov_b32 v141, v143
    v_cvt_pk_bf16_f32 v144, v140, v141
    buffer_store_dword v144, v22, s[16:19], s41 offen
    s_add_u32 s41, s41, 2560
    v_mul_f32 v142, v130, v77
    v_fma_f32 v142, -v131, v93, v142
    v_mul_f32 v143, v130, v93
    v_fma_f32 v143, v131, v77, v143
    v_fma_f32 v142, v128, v140, v142
    v_fma_f32 v143, v128, v141, v143
    v_fma_f32 v142, -v129, v141, v142
    v_fma_f32 v143, v129, v140, v143
    v_mov_b32 v140, v142
    v_mov_b32 v141, v143
    v_cvt_pk_bf16_f32 v144, v140, v141
    buffer_store_dword v144, v22, s[16:19], s41 offen
    s_add_u32 s41, s41, 2560
    v_mul_f32 v142, v130, v78
    v_fma_f32 v142, -v131, v94, v142
    v_mul_f32 v143, v130, v94
    v_fma_f32 v143, v131, v78, v143
    v_fma_f32 v142, v128, v140, v142
    v_fma_f32 v143, v128, v141, v143
    v_fma_f32 v142, -v129, v141, v142
    v_fma_f32 v143, v129, v140, v143
    v_mov_b32 v140, v142
    v_mov_b32 v141, v143
    v_cvt_pk_bf16_f32 v144, v140, v141
    buffer_store_dword v144, v22, s[16:19], s41 offen
    s_add_u32 s41, s41, 2560
    v_mul_f32 v142, v130, v79
    v_fma_f32 v142, -v131, v95, v142
    v_mul_f32 v143, v130, v95
    v_fma_f32 v143, v131, v79, v143
    v_fma_f32 v142, v128, v140, v142
    v_fma_f32 v143, v128, v141, v143
    v_fma_f32 v142, -v129, v141, v142
    v_fma_f32 v143, v129, v140, v143
    v_mov_b32 v140, v142
    v_mov_b32 v141, v143
    v_cvt_pk_bf16_f32 v144, v140, v141
    buffer_store_dword v144, v22, s[16:19], s41 offen
    s_add_u32 s41, s41, 2560
    v_mul_f32 v142, v130, v96
    v_fma_f32 v142, -v131, v112, v142
    v_mul_f32 v143, v130, v112
    v_fma_f32 v143, v131, v96, v143
    v_fma_f32 v142, v128, v140, v142
    v_fma_f32 v143, v128, v141, v143
    v_fma_f32 v142, -v129, v141, v142
    v_fma_f32 v143, v129, v140, v143
    v_mov_b32 v140, v142
    v_mov_b32 v141, v143
    v_cvt_pk_bf16_f32 v144, v140, v141
    buffer_store_dword v144, v22, s[16:19], s41 offen
    s_add_u32 s41, s41, 2560
    v_mul_f32 v142, v130, v97
    v_fma_f32 v142, -v131, v113, v142
    v_mul_f32 v143, v130, v113
    v_fma_f32 v143, v131, v97, v143
    v_fma_f32 v142, v128, v140, v142
    v_fma_f32 v143, v128, v141, v143
    v_fma_f32 v142, -v129, v141, v142
    v_fma_f32 v143, v129, v140, v143
    v_mov_b32 v140, v142
    v_mov_b32 v141, v143
    v_cvt_pk_bf16_f32 v144, v140, v141
    buffer_store_dword v144, v22, s[16:19], s41 offen
    s_add_u32 s41, s41, 2560
    v_mul_f32 v142, v130, v98
    v_fma_f32 v142, -v131, v114, v142
    v_mul_f32 v143, v130, v114
    v_fma_f32 v143, v131, v98, v143
    v_fma_f32 v142, v128, v140, v142
    v_fma_f32 v143, v128, v141, v143
    v_fma_f32 v142, -v129, v141, v142
    v_fma_f32 v143, v129, v140, v143
    v_mov_b32 v140, v142
    v_mov_b32 v141, v143
    v_cvt_pk_bf16_f32 v144, v140, v141
    buffer_store_dword v144, v22, s[16:19], s41 offen
    s_add_u32 s41, s41, 2560
    v_mul_f32 v142, v130, v99
    v_fma_f32 v142, -v131, v115, v142
    v_mul_f32 v143, v130, v115
    v_fma_f32 v143, v131, v99, v143
    v_fma_f32 v142, v128, v140, v142
    v_fma_f32 v143, v128, v141, v143
    v_fma_f32 v142, -v129, v141, v142
    v_fma_f32 v143, v129, v140, v143
    v_mov_b32 v140, v142
    v_mov_b32 v141, v143
    v_cvt_pk_bf16_f32 v144, v140, v141
    buffer_store_dword v144, v22, s[16:19], s41 offen
    s_add_u32 s41, s41, 2560
    v_mul_f32 v142, v130, v100
    v_fma_f32 v142, -v131, v116, v142
    v_mul_f32 v143, v130, v116
    v_fma_f32 v143, v131, v100, v143
    v_fma_f32 v142, v128, v140, v142
    v_fma_f32 v143, v128, v141, v143
    v_fma_f32 v142, -v129, v141, v142
    v_fma_f32 v143, v129, v140, v143
    v_mov_b32 v140, v142
    v_mov_b32 v141, v143
    v_cvt_pk_bf16_f32 v144, v140, v141
    buffer_store_dword v144, v22, s[16:19], s41 offen
    s_add_u32 s41, s41, 2560
    v_mul_f32 v142, v130, v101
    v_fma_f32 v142, -v131, v117, v142
    v_mul_f32 v143, v130, v117
    v_fma_f32 v143, v131, v101, v143
    v_fma_f32 v142, v128, v140, v142
    v_fma_f32 v143, v128, v141, v143
    v_fma_f32 v142, -v129, v141, v142
    v_fma_f32 v143, v129, v140, v143
    v_mov_b32 v140, v142
    v_mov_b32 v141, v143
    v_cvt_pk_bf16_f32 v144, v140, v141
    buffer_store_dword v144, v22, s[16:19], s41 offen
    s_add_u32 s41, s41, 2560
    v_mul_f32 v142, v130, v102
    v_fma_f32 v142, -v131, v118, v142
    v_mul_f32 v143, v130, v118
    v_fma_f32 v143, v131, v102, v143
    v_fma_f32 v142, v128, v140, v142
    v_fma_f32 v143, v128, v141, v143
    v_fma_f32 v142, -v129, v141, v142
    v_fma_f32 v143, v129, v140, v143
    v_mov_b32 v140, v142
    v_mov_b32 v141, v143
    v_cvt_pk_bf16_f32 v144, v140, v141
    buffer_store_dword v144, v22, s[16:19], s41 offen
    s_add_u32 s41, s41, 2560
    v_mul_f32 v142, v130, v103
    v_fma_f32 v142, -v131, v119, v142
    v_mul_f32 v143, v130, v119
    v_fma_f32 v143, v131, v103, v143
    v_fma_f32 v142, v128, v140, v142
    v_fma_f32 v143, v128, v141, v143
    v_fma_f32 v142, -v129, v141, v142
    v_fma_f32 v143, v129, v140, v143
    v_mov_b32 v140, v142
    v_mov_b32 v141, v143
    v_cvt_pk_bf16_f32 v144, v140, v141
    buffer_store_dword v144, v22, s[16:19], s41 offen
    s_add_u32 s41, s41, 2560
    v_mul_f32 v142, v130, v104
    v_fma_f32 v142, -v131, v120, v142
    v_mul_f32 v143, v130, v120
    v_fma_f32 v143, v131, v104, v143
    v_fma_f32 v142, v128, v140, v142
    v_fma_f32 v143, v128, v141, v143
    v_fma_f32 v142, -v129, v141, v142
    v_fma_f32 v143, v129, v140, v143
    v_mov_b32 v140, v142
    v_mov_b32 v141, v143
    v_cvt_pk_bf16_f32 v144, v140, v141
    buffer_store_dword v144, v22, s[16:19], s41 offen
    s_add_u32 s41, s41, 2560
    v_mul_f32 v142, v130, v105
    v_fma_f32 v142, -v131, v121, v142
    v_mul_f32 v143, v130, v121
    v_fma_f32 v143, v131, v105, v143
    v_fma_f32 v142, v128, v140, v142
    v_fma_f32 v143, v128, v141, v143
    v_fma_f32 v142, -v129, v141, v142
    v_fma_f32 v143, v129, v140, v143
    v_mov_b32 v140, v142
    v_mov_b32 v141, v143
    v_cvt_pk_bf16_f32 v144, v140, v141
    buffer_store_dword v144, v22, s[16:19], s41 offen
    s_add_u32 s41, s41, 2560
    v_mul_f32 v142, v130, v106
    v_fma_f32 v142, -v131, v122, v142
    v_mul_f32 v143, v130, v122
    v_fma_f32 v143, v131, v106, v143
    v_fma_f32 v142, v128, v140, v142
    v_fma_f32 v143, v128, v141, v143
    v_fma_f32 v142, -v129, v141, v142
    v_fma_f32 v143, v129, v140, v143
    v_mov_b32 v140, v142
    v_mov_b32 v141, v143
    v_cvt_pk_bf16_f32 v144, v140, v141
    buffer_store_dword v144, v22, s[16:19], s41 offen
    s_add_u32 s41, s41, 2560
    v_mul_f32 v142, v130, v107
    v_fma_f32 v142, -v131, v123, v142
    v_mul_f32 v143, v130, v123
    v_fma_f32 v143, v131, v107, v143
    v_fma_f32 v142, v128, v140, v142
    v_fma_f32 v143, v128, v141, v143
    v_fma_f32 v142, -v129, v141, v142
    v_fma_f32 v143, v129, v140, v143
    v_mov_b32 v140, v142
    v_mov_b32 v141, v143
    v_cvt_pk_bf16_f32 v144, v140, v141
    buffer_store_dword v144, v22, s[16:19], s41 offen
    s_add_u32 s41, s41, 2560
    v_mul_f32 v142, v130, v108
    v_fma_f32 v142, -v131, v124, v142
    v_mul_f32 v143, v130, v124
    v_fma_f32 v143, v131, v108, v143
    v_fma_f32 v142, v128, v140, v142
    v_fma_f32 v143, v128, v141, v143
    v_fma_f32 v142, -v129, v141, v142
    v_fma_f32 v143, v129, v140, v143
    v_mov_b32 v140, v142
    v_mov_b32 v141, v143
    v_cvt_pk_bf16_f32 v144, v140, v141
    buffer_store_dword v144, v22, s[16:19], s41 offen
    s_add_u32 s41, s41, 2560
    v_mul_f32 v142, v130, v109
    v_fma_f32 v142, -v131, v125, v142
    v_mul_f32 v143, v130, v125
    v_fma_f32 v143, v131, v109, v143
    v_fma_f32 v142, v128, v140, v142
    v_fma_f32 v143, v128, v141, v143
    v_fma_f32 v142, -v129, v141, v142
    v_fma_f32 v143, v129, v140, v143
    v_mov_b32 v140, v142
    v_mov_b32 v141, v143
    v_cvt_pk_bf16_f32 v144, v140, v141
    buffer_store_dword v144, v22, s[16:19], s41 offen
    s_add_u32 s41, s41, 2560
    v_mul_f32 v142, v130, v110
    v_fma_f32 v142, -v131, v126, v142
    v_mul_f32 v143, v130, v126
    v_fma_f32 v143, v131, v110, v143
    v_fma_f32 v142, v128, v140, v142
    v_fma_f32 v143, v128, v141, v143
    v_fma_f32 v142, -v129, v141, v142
    v_fma_f32 v143, v129, v140, v143
    v_mov_b32 v140, v142
    v_mov_b32 v141, v143
    v_cvt_pk_bf16_f32 v144, v140, v141
    buffer_store_dword v144, v22, s[16:19], s41 offen
    s_add_u32 s41, s41, 2560
    v_mul_f32 v142, v130, v111
    v_fma_f32 v142, -v131, v127, v142
    v_mul_f32 v143, v130, v127
    v_fma_f32 v143, v131, v111, v143
    v_fma_f32 v142, v128, v140, v142
    v_fma_f32 v143, v128, v141, v143
    v_fma_f32 v142, -v129, v141, v142
    v_fma_f32 v143, v129, v140, v143
    v_mov_b32 v140, v142
    v_mov_b32 v141, v143
    v_cvt_pk_bf16_f32 v144, v140, v141
    buffer_store_dword v144, v22, s[16:19], s41 offen
    s_add_u32 s41, s41, 2560
    v_lshrrev_b32 v21, 5, v21
    v_mul_u32_u24 v21, 640, v21
    v_add_u32 v21, v21, v20
    v_lshlrev_b32 v21, 3, v21
    buffer_store_dwordx2 v[140:141], v21, s[20:23], 0 offen
K1_END:
    s_endpgm
.section .rodata,"a"
.p2align 6
.amdhsa_kernel k1_kernel
  .amdhsa_next_free_vgpr 148
  .amdhsa_next_free_sgpr 96
  .amdhsa_accum_offset 148
  .amdhsa_group_segment_fixed_size 0
  .amdhsa_kernarg_size 128
  .amdhsa_user_sgpr_count 2
  .amdhsa_user_sgpr_kernarg_segment_ptr 1
  .amdhsa_system_sgpr_workgroup_id_x 1
.end_amdhsa_kernel
.text
.globl k2_kernel
.p2align 8
.type k2_kernel,@function
k2_kernel:
    s_cmp_ge_u32 s2, 448
    s_cbranch_scc1 K2_END
    s_load_dwordx16 s[44:59], s[0:1], 0
    s_load_dwordx2 s[60:61], s[0:1], 96
    s_load_dwordx2 s[62:63], s[0:1], 120
    s_waitcnt lgkmcnt(0)
    s_cmp_ge_u32 s2, 320
    s_cbranch_scc1 K2_GATE
    s_mul_hi_u32 s36, s2, 0x33333334
    s_mul_i32 s37, s36, 5
    s_sub_u32 s37, s2, s37
    s_mov_b32 s4, s62
    s_and_b32 s5, s63, 0xffff
    s_mov_b32 s6, 5242880
    s_mov_b32 s7, 0x00020000
    s_add_u32 s64, s62, 5242880
    s_addc_u32 s65, s63, 0
    s_mov_b32 s8, s64
    s_and_b32 s9, s65, 0xffff
    s_mov_b32 s10, 327680
    s_mov_b32 s11, 0x00020000
    s_add_u32 s64, s62, 13631488
    s_addc_u32 s65, s63, 0
    s_mov_b32 s12, s64
    s_and_b32 s13, s65, 0xffff
    s_mov_b32 s14, 5242880
    s_mov_b32 s15, 0x00020000
    s_mov_b32 s24, s46
    s_and_b32 s25, s47, 0xffff
    s_mov_b32 s26, 1280
    s_mov_b32 s27, 0x00020000
    s_mov_b32 s28, s48
    s_and_b32 s29, s49, 0xffff
    s_mov_b32 s30, 1280
    s_mov_b32 s31, 0x00020000
    s_mov_b32 s32, s58
    s_and_b32 s33, s59, 0xffff
    s_mov_b32 s34, 1280
    s_mov_b32 s35, 0x00020000
    s_lshl_b32 s41, s37, 7
    v_add_u32 v1, s41, v0
    v_lshlrev_b32 v20, 1, v1
    buffer_load_ushort v21, v20, s[24:27], 0 offen
    buffer_load_ushort v22, v20, s[28:31], 0 offen
    buffer_load_ushort v23, v20, s[32:35], 0 offen
    s_waitcnt vmcnt(0)
    v_lshlrev_b32 v21, 16, v21
    v_lshlrev_b32 v22, 16, v22
    v_lshlrev_b32 v23, 16, v23
    v_mul_f32 v23, 0x3fb8aa3b, v23
    v_exp_f32 v23, v23
    s_nop 1
    v_cvt_pk_bf16_f32 v23, v23, v23
    v_lshlrev_b32 v23, 16, v23
    v_mul_f32 v24, v23, v21
    v_mul_f32 v25, v23, v22
    v_mul_f32 v24, 0x3fb8aa3b, v24
    v_exp_f32 v24, v24
    v_mul_f32 v25, 0.15915494, v25
    v_cos_f32 v16, v25
    v_sin_f32 v17, v25
    s_nop 1
    v_mul_f32 v16, v16, v24
    v_mul_f32 v17, v17, v24
    v_add_f32 v24, -1.0, v16
    v_mul_f32 v25, v21, v21
    v_fma_f32 v25, v22, v22, v25
    v_rcp_f32 v25, v25
    v_mul_f32 v26, v24, v21
    v_fma_f32 v26, v17, v22, v26
    v_mul_f32 v27, v17, v21
    v_fma_f32 v27, -v24, v22, v27
    v_mul_f32 v18, v26, v25
    v_mul_f32 v19, v27, v25
    v_mov_b32 v20, v16
    v_mov_b32 v21, v17
    v_mul_f32 v22, v20, v20
    v_fma_f32 v22, -v21, v21, v22
    v_mul_f32 v23, v20, v21
    v_add_f32 v21, v23, v23
    v_mov_b32 v20, v22
    v_mul_f32 v22, v20, v20
    v_fma_f32 v22, -v21, v21, v22
    v_mul_f32 v23, v20, v21
    v_add_f32 v21, v23, v23
    v_mov_b32 v20, v22
    v_mul_f32 v22, v20, v20
    v_fma_f32 v22, -v21, v21, v22
    v_mul_f32 v23, v20, v21
    v_add_f32 v21, v23, v23
    v_mov_b32 v20, v22
    v_mul_f32 v22, v20, v20
    v_fma_f32 v22, -v21, v21, v22
    v_mul_f32 v23, v20, v21
    v_add_f32 v21, v23, v23
    v_mov_b32 v20, v22
    v_mul_f32 v22, v20, v20
    v_fma_f32 v22, -v21, v21, v22
    v_mul_f32 v23, v20, v21
    v_add_f32 v21, v23, v23
    v_mov_b32 v20, v22
    v_mov_b32 v24, 0
    v_mov_b32 v25, 0
    v_lshlrev_b32 v2, 3, v1
    s_mov_b32 s40, 0
    s_mov_b32 s41, 0
K2_CL:
    s_cmp_ge_u32 s40, s36
    s_cbranch_scc1 K2_CD
    buffer_load_dwordx2 v[32:33], v2, s[8:11], s41 offen offset:0
    s_add_u32 s41, s41, 5120
    buffer_load_dwordx2 v[34:35], v2, s[8:11], s41 offen
    s_add_u32 s41, s41, 5120
    buffer_load_dwordx2 v[36:37], v2, s[8:11], s41 offen
    s_add_u32 s41, s41, 5120
    buffer_load_dwordx2 v[38:39], v2, s[8:11], s41 offen
    s_add_u32 s41, s41, 5120
    buffer_load_dwordx2 v[40:41], v2, s[8:11], s41 offen
    s_add_u32 s41, s41, 5120
    buffer_load_dwordx2 v[42:43], v2, s[8:11], s41 offen
    s_add_u32 s41, s41, 5120
    buffer_load_dwordx2 v[44:45], v2, s[8:11], s41 offen
    s_add_u32 s41, s41, 5120
    buffer_load_dwordx2 v[46:47], v2, s[8:11], s41 offen
    s_add_u32 s41, s41, 5120
    s_waitcnt vmcnt(7)
    s_cmp_ge_u32 s40, s36
    s_cbranch_scc1 K2_CD
    v_mul_f32 v22, v20, v24
    v_fma_f32 v22, -v21, v25, v22
    v_mul_f32 v23, v20, v25
    v_fma_f32 v23, v21, v24, v23
    v_add_f32 v24, v22, v32
    v_add_f32 v25, v23, v33
    s_add_u32 s40, s40, 1
    s_waitcnt vmcnt(6)
    s_cmp_ge_u32 s40, s36
    s_cbranch_scc1 K2_CD
    v_mul_f32 v22, v20, v24
    v_fma_f32 v22, -v21, v25, v22
    v_mul_f32 v23, v20, v25
    v_fma_f32 v23, v21, v24, v23
    v_add_f32 v24, v22, v34
    v_add_f32 v25, v23, v35
    s_add_u32 s40, s40, 1
    s_waitcnt vmcnt(5)
    s_cmp_ge_u32 s40, s36
    s_cbranch_scc1 K2_CD
    v_mul_f32 v22, v20, v24
    v_fma_f32 v22, -v21, v25, v22
    v_mul_f32 v23, v20, v25
    v_fma_f32 v23, v21, v24, v23
    v_add_f32 v24, v22, v36
    v_add_f32 v25, v23, v37
    s_add_u32 s40, s40, 1
    s_waitcnt vmcnt(4)
    s_cmp_ge_u32 s40, s36
    s_cbranch_scc1 K2_CD
    v_mul_f32 v22, v20, v24
    v_fma_f32 v22, -v21, v25, v22
    v_mul_f32 v23, v20, v25
    v_fma_f32 v23, v21, v24, v23
    v_add_f32 v24, v22, v38
    v_add_f32 v25, v23, v39
    s_add_u32 s40, s40, 1
    s_waitcnt vmcnt(3)
    s_cmp_ge_u32 s40, s36
    s_cbranch_scc1 K2_CD
    v_mul_f32 v22, v20, v24
    v_fma_f32 v22, -v21, v25, v22
    v_mul_f32 v23, v20, v25
    v_fma_f32 v23, v21, v24, v23
    v_add_f32 v24, v22, v40
    v_add_f32 v25, v23, v41
    s_add_u32 s40, s40, 1
    s_waitcnt vmcnt(2)
    s_cmp_ge_u32 s40, s36
    s_cbranch_scc1 K2_CD
    v_mul_f32 v22, v20, v24
    v_fma_f32 v22, -v21, v25, v22
    v_mul_f32 v23, v20, v25
    v_fma_f32 v23, v21, v24, v23
    v_add_f32 v24, v22, v42
    v_add_f32 v25, v23, v43
    s_add_u32 s40, s40, 1
    s_waitcnt vmcnt(1)
    s_cmp_ge_u32 s40, s36
    s_cbranch_scc1 K2_CD
    v_mul_f32 v22, v20, v24
    v_fma_f32 v22, -v21, v25, v22
    v_mul_f32 v23, v20, v25
    v_fma_f32 v23, v21, v24, v23
    v_add_f32 v24, v22, v44
    v_add_f32 v25, v23, v45
    s_add_u32 s40, s40, 1
    s_waitcnt vmcnt(0)
    s_cmp_ge_u32 s40, s36
    s_cbranch_scc1 K2_CD
    v_mul_f32 v22, v20, v24
    v_fma_f32 v22, -v21, v25, v22
    v_mul_f32 v23, v20, v25
    v_fma_f32 v23, v21, v24, v23
    v_add_f32 v24, v22, v46
    v_add_f32 v25, v23, v47
    s_add_u32 s40, s40, 1
    s_branch K2_CL
K2_CD:
    s_waitcnt vmcnt(0)
    v_mul_f32 v22, v16, v24
    v_fma_f32 v22, -v17, v25, v22
    v_mul_f32 v23, v16, v25
    v_fma_f32 v23, v17, v24, v23
    s_lshl_b32 s41, s36, 5
    s_mul_i32 s42, s41, 2560
    v_lshlrev_b32 v3, 2, v1
    v_lshlrev_b32 v4, 1, v1
    buffer_load_dword v32, v3, s[4:7], s42 offen
    s_add_u32 s42, s42, 2560
    buffer_load_dword v33, v3, s[4:7], s42 offen
    s_add_u32 s42, s42, 2560
    buffer_load_dword v34, v3, s[4:7], s42 offen
    s_add_u32 s42, s42, 2560
    buffer_load_dword v35, v3, s[4:7], s42 offen
    s_add_u32 s42, s42, 2560
    buffer_load_dword v36, v3, s[4:7], s42 offen
    s_add_u32 s42, s42, 2560
    buffer_load_dword v37, v3, s[4:7], s42 offen
    s_add_u32 s42, s42, 2560
    buffer_load_dword v38, v3, s[4:7], s42 offen
    s_add_u32 s42, s42, 2560
    buffer_load_dword v39, v3, s[4:7], s42 offen
    s_add_u32 s42, s42, 2560
    buffer_load_dword v40, v3, s[4:7], s42 offen
    s_add_u32 s42, s42, 2560
    buffer_load_dword v41, v3, s[4:7], s42 offen
    s_add_u32 s42, s42, 2560
    buffer_load_dword v42, v3, s[4:7], s42 offen
    s_add_u32 s42, s42, 2560
    buffer_load_dword v43, v3, s[4:7], s42 offen
    s_add_u32 s42, s42, 2560
    buffer_load_dword v44, v3, s[4:7], s42 offen
    s_add_u32 s42, s42, 2560
    buffer_load_dword v45, v3, s[4:7], s42 offen
    s_add_u32 s42, s42, 2560
    buffer_load_dword v46, v3, s[4:7], s42 offen
    s_add_u32 s42, s42, 2560
    buffer_load_dword v47, v3, s[4:7], s42 offen
    s_add_u32 s42, s42, 2560
    buffer_load_dword v48, v3, s[4:7], s42 offen
    s_add_u32 s42, s42, 2560
    buffer_load_dword v49, v3, s[4:7], s42 offen
    s_add_u32 s42, s42, 2560
    buffer_load_dword v50, v3, s[4:7], s42 offen
    s_add_u32 s42, s42, 2560
    buffer_load_dword v51, v3, s[4:7], s42 offen
    s_add_u32 s42, s42, 2560
    buffer_load_dword v52, v3, s[4:7], s42 offen
    s_add_u32 s42, s42, 2560
    buffer_load_dword v53, v3, s[4:7], s42 offen
    s_add_u32 s42, s42, 2560
    buffer_load_dword v54, v3, s[4:7], s42 offen
    s_add_u32 s42, s42, 2560
    buffer_load_dword v55, v3, s[4:7], s42 offen
    s_add_u32 s42, s42, 2560
    buffer_load_dword v56, v3, s[4:7], s42 offen
    s_add_u32 s42, s42, 2560
    buffer_load_dword v57, v3, s[4:7], s42 offen
    s_add_u32 s42, s42, 2560
    buffer_load_dword v58, v3, s[4:7], s42 offen
    s_add_u32 s42, s42, 2560
    buffer_load_dword v59, v3, s[4:7], s42 offen
    s_add_u32 s42, s42, 2560
    buffer_load_dword v60, v3, s[4:7], s42 offen
    s_add_u32 s42, s42, 2560
    buffer_load_dword v61, v3, s[4:7], s42 offen
    s_add_u32 s42, s42, 2560
    buffer_load_dword v62, v3, s[4:7], s42 offen
    s_add_u32 s42, s42, 2560
    buffer_load_dword v63, v3, s[4:7], s42 offen
    s_add_u32 s42, s42, 2560
    s_mul_i32 s42, s41, 2560
    s_waitcnt vmcnt(31)
    v_lshlrev_b32 v26, 16, v32
    v_and_b32 v27, 0xffff0000, v32
    v_add_f32 v26, v26, v22
    v_add_f32 v27, v27, v23
    v_add_f32 v26, v26, v26
    v_mul_f32 v27, -2.0, v27
    v_cvt_pk_bf16_f32 v26, v26, v27
    v_lshrrev_b32 v27, 16, v26
    buffer_store_short v26, v4, s[12:15], s42 offen
    buffer_store_short v27, v4, s[12:15], s42 offen offset:1280
    s_add_u32 s42, s42, 2560
    v_mul_f32 v28, v16, v22
    v_fma_f32 v28, -v17, v23, v28
    v_mul_f32 v29, v16, v23
    v_fma_f32 v23, v17, v22, v29
    v_mov_b32 v22, v28
    s_waitcnt vmcnt(30)
    v_lshlrev_b32 v26, 16, v33
    v_and_b32 v27, 0xffff0000, v33
    v_add_f32 v26, v26, v22
    v_add_f32 v27, v27, v23
    v_add_f32 v26, v26, v26
    v_mul_f32 v27, -2.0, v27
    v_cvt_pk_bf16_f32 v26, v26, v27
    v_lshrrev_b32 v27, 16, v26
    buffer_store_short v26, v4, s[12:15], s42 offen
    buffer_store_short v27, v4, s[12:15], s42 offen offset:1280
    s_add_u32 s42, s42, 2560
    v_mul_f32 v28, v16, v22
    v_fma_f32 v28, -v17, v23, v28
    v_mul_f32 v29, v16, v23
    v_fma_f32 v23, v17, v22, v29
    v_mov_b32 v22, v28
    s_waitcnt vmcnt(29)
    v_lshlrev_b32 v26, 16, v34
    v_and_b32 v27, 0xffff0000, v34
    v_add_f32 v26, v26, v22
    v_add_f32 v27, v27, v23
    v_add_f32 v26, v26, v26
    v_mul_f32 v27, -2.0, v27
    v_cvt_pk_bf16_f32 v26, v26, v27
    v_lshrrev_b32 v27, 16, v26
    buffer_store_short v26, v4, s[12:15], s42 offen
    buffer_store_short v27, v4, s[12:15], s42 offen offset:1280
    s_add_u32 s42, s42, 2560
    v_mul_f32 v28, v16, v22
    v_fma_f32 v28, -v17, v23, v28
    v_mul_f32 v29, v16, v23
    v_fma_f32 v23, v17, v22, v29
    v_mov_b32 v22, v28
    s_waitcnt vmcnt(28)
    v_lshlrev_b32 v26, 16, v35
    v_and_b32 v27, 0xffff0000, v35
    v_add_f32 v26, v26, v22
    v_add_f32 v27, v27, v23
    v_add_f32 v26, v26, v26
    v_mul_f32 v27, -2.0, v27
    v_cvt_pk_bf16_f32 v26, v26, v27
    v_lshrrev_b32 v27, 16, v26
    buffer_store_short v26, v4, s[12:15], s42 offen
    buffer_store_short v27, v4, s[12:15], s42 offen offset:1280
    s_add_u32 s42, s42, 2560
    v_mul_f32 v28, v16, v22
    v_fma_f32 v28, -v17, v23, v28
    v_mul_f32 v29, v16, v23
    v_fma_f32 v23, v17, v22, v29
    v_mov_b32 v22, v28
    s_waitcnt vmcnt(27)
    v_lshlrev_b32 v26, 16, v36
    v_and_b32 v27, 0xffff0000, v36
    v_add_f32 v26, v26, v22
    v_add_f32 v27, v27, v23
    v_add_f32 v26, v26, v26
    v_mul_f32 v27, -2.0, v27
    v_cvt_pk_bf16_f32 v26, v26, v27
    v_lshrrev_b32 v27, 16, v26
    buffer_store_short v26, v4, s[12:15], s42 offen
    buffer_store_short v27, v4, s[12:15], s42 offen offset:1280
    s_add_u32 s42, s42, 2560
    v_mul_f32 v28, v16, v22
    v_fma_f32 v28, -v17, v23, v28
    v_mul_f32 v29, v16, v23
    v_fma_f32 v23, v17, v22, v29
    v_mov_b32 v22, v28
    s_waitcnt vmcnt(26)
    v_lshlrev_b32 v26, 16, v37
    v_and_b32 v27, 0xffff0000, v37
    v_add_f32 v26, v26, v22
    v_add_f32 v27, v27, v23
    v_add_f32 v26, v26, v26
    v_mul_f32 v27, -2.0, v27
    v_cvt_pk_bf16_f32 v26, v26, v27
    v_lshrrev_b32 v27, 16, v26
    buffer_store_short v26, v4, s[12:15], s42 offen
    buffer_store_short v27, v4, s[12:15], s42 offen offset:1280
    s_add_u32 s42, s42, 2560
    v_mul_f32 v28, v16, v22
    v_fma_f32 v28, -v17, v23, v28
    v_mul_f32 v29, v16, v23
    v_fma_f32 v23, v17, v22, v29
    v_mov_b32 v22, v28
    s_waitcnt vmcnt(25)
    v_lshlrev_b32 v26, 16, v38
    v_and_b32 v27, 0xffff0000, v38
    v_add_f32 v26, v26, v22
    v_add_f32 v27, v27, v23
    v_add_f32 v26, v26, v26
    v_mul_f32 v27, -2.0, v27
    v_cvt_pk_bf16_f32 v26, v26, v27
    v_lshrrev_b32 v27, 16, v26
    buffer_store_short v26, v4, s[12:15], s42 offen
    buffer_store_short v27, v4, s[12:15], s42 offen offset:1280
    s_add_u32 s42, s42, 2560
    v_mul_f32 v28, v16, v22
    v_fma_f32 v28, -v17, v23, v28
    v_mul_f32 v29, v16, v23
    v_fma_f32 v23, v17, v22, v29
    v_mov_b32 v22, v28
    s_waitcnt vmcnt(24)
    v_lshlrev_b32 v26, 16, v39
    v_and_b32 v27, 0xffff0000, v39
    v_add_f32 v26, v26, v22
    v_add_f32 v27, v27, v23
    v_add_f32 v26, v26, v26
    v_mul_f32 v27, -2.0, v27
    v_cvt_pk_bf16_f32 v26, v26, v27
    v_lshrrev_b32 v27, 16, v26
    buffer_store_short v26, v4, s[12:15], s42 offen
    buffer_store_short v27, v4, s[12:15], s42 offen offset:1280
    s_add_u32 s42, s42, 2560
    v_mul_f32 v28, v16, v22
    v_fma_f32 v28, -v17, v23, v28
    v_mul_f32 v29, v16, v23
    v_fma_f32 v23, v17, v22, v29
    v_mov_b32 v22, v28
    s_waitcnt vmcnt(23)
    v_lshlrev_b32 v26, 16, v40
    v_and_b32 v27, 0xffff0000, v40
    v_add_f32 v26, v26, v22
    v_add_f32 v27, v27, v23
    v_add_f32 v26, v26, v26
    v_mul_f32 v27, -2.0, v27
    v_cvt_pk_bf16_f32 v26, v26, v27
    v_lshrrev_b32 v27, 16, v26
    buffer_store_short v26, v4, s[12:15], s42 offen
    buffer_store_short v27, v4, s[12:15], s42 offen offset:1280
    s_add_u32 s42, s42, 2560
    v_mul_f32 v28, v16, v22
    v_fma_f32 v28, -v17, v23, v28
    v_mul_f32 v29, v16, v23
    v_fma_f32 v23, v17, v22, v29
    v_mov_b32 v22, v28
    s_waitcnt vmcnt(22)
    v_lshlrev_b32 v26, 16, v41
    v_and_b32 v27, 0xffff0000, v41
    v_add_f32 v26, v26, v22
    v_add_f32 v27, v27, v23
    v_add_f32 v26, v26, v26
    v_mul_f32 v27, -2.0, v27
    v_cvt_pk_bf16_f32 v26, v26, v27
    v_lshrrev_b32 v27, 16, v26
    buffer_store_short v26, v4, s[12:15], s42 offen
    buffer_store_short v27, v4, s[12:15], s42 offen offset:1280
    s_add_u32 s42, s42, 2560
    v_mul_f32 v28, v16, v22
    v_fma_f32 v28, -v17, v23, v28
    v_mul_f32 v29, v16, v23
    v_fma_f32 v23, v17, v22, v29
    v_mov_b32 v22, v28
    s_waitcnt vmcnt(21)
    v_lshlrev_b32 v26, 16, v42
    v_and_b32 v27, 0xffff0000, v42
    v_add_f32 v26, v26, v22
    v_add_f32 v27, v27, v23
    v_add_f32 v26, v26, v26
    v_mul_f32 v27, -2.0, v27
    v_cvt_pk_bf16_f32 v26, v26, v27
    v_lshrrev_b32 v27, 16, v26
    buffer_store_short v26, v4, s[12:15], s42 offen
    buffer_store_short v27, v4, s[12:15], s42 offen offset:1280
    s_add_u32 s42, s42, 2560
    v_mul_f32 v28, v16, v22
    v_fma_f32 v28, -v17, v23, v28
    v_mul_f32 v29, v16, v23
    v_fma_f32 v23, v17, v22, v29
    v_mov_b32 v22, v28
    s_waitcnt vmcnt(20)
    v_lshlrev_b32 v26, 16, v43
    v_and_b32 v27, 0xffff0000, v43
    v_add_f32 v26, v26, v22
    v_add_f32 v27, v27, v23
    v_add_f32 v26, v26, v26
    v_mul_f32 v27, -2.0, v27
    v_cvt_pk_bf16_f32 v26, v26, v27
    v_lshrrev_b32 v27, 16, v26
    buffer_store_short v26, v4, s[12:15], s42 offen
    buffer_store_short v27, v4, s[12:15], s42 offen offset:1280
    s_add_u32 s42, s42, 2560
    v_mul_f32 v28, v16, v22
    v_fma_f32 v28, -v17, v23, v28
    v_mul_f32 v29, v16, v23
    v_fma_f32 v23, v17, v22, v29
    v_mov_b32 v22, v28
    s_waitcnt vmcnt(19)
    v_lshlrev_b32 v26, 16, v44
    v_and_b32 v27, 0xffff0000, v44
    v_add_f32 v26, v26, v22
    v_add_f32 v27, v27, v23
    v_add_f32 v26, v26, v26
    v_mul_f32 v27, -2.0, v27
    v_cvt_pk_bf16_f32 v26, v26, v27
    v_lshrrev_b32 v27, 16, v26
    buffer_store_short v26, v4, s[12:15], s42 offen
    buffer_store_short v27, v4, s[12:15], s42 offen offset:1280
    s_add_u32 s42, s42, 2560
    v_mul_f32 v28, v16, v22
    v_fma_f32 v28, -v17, v23, v28
    v_mul_f32 v29, v16, v23
    v_fma_f32 v23, v17, v22, v29
    v_mov_b32 v22, v28
    s_waitcnt vmcnt(18)
    v_lshlrev_b32 v26, 16, v45
    v_and_b32 v27, 0xffff0000, v45
    v_add_f32 v26, v26, v22
    v_add_f32 v27, v27, v23
    v_add_f32 v26, v26, v26
    v_mul_f32 v27, -2.0, v27
    v_cvt_pk_bf16_f32 v26, v26, v27
    v_lshrrev_b32 v27, 16, v26
    buffer_store_short v26, v4, s[12:15], s42 offen
    buffer_store_short v27, v4, s[12:15], s42 offen offset:1280
    s_add_u32 s42, s42, 2560
    v_mul_f32 v28, v16, v22
    v_fma_f32 v28, -v17, v23, v28
    v_mul_f32 v29, v16, v23
    v_fma_f32 v23, v17, v22, v29
    v_mov_b32 v22, v28
    s_waitcnt vmcnt(17)
    v_lshlrev_b32 v26, 16, v46
    v_and_b32 v27, 0xffff0000, v46
    v_add_f32 v26, v26, v22
    v_add_f32 v27, v27, v23
    v_add_f32 v26, v26, v26
    v_mul_f32 v27, -2.0, v27
    v_cvt_pk_bf16_f32 v26, v26, v27
    v_lshrrev_b32 v27, 16, v26
    buffer_store_short v26, v4, s[12:15], s42 offen
    buffer_store_short v27, v4, s[12:15], s42 offen offset:1280
    s_add_u32 s42, s42, 2560
    v_mul_f32 v28, v16, v22
    v_fma_f32 v28, -v17, v23, v28
    v_mul_f32 v29, v16, v23
    v_fma_f32 v23, v17, v22, v29
    v_mov_b32 v22, v28
    s_waitcnt vmcnt(16)
    v_lshlrev_b32 v26, 16, v47
    v_and_b32 v27, 0xffff0000, v47
    v_add_f32 v26, v26, v22
    v_add_f32 v27, v27, v23
    v_add_f32 v26, v26, v26
    v_mul_f32 v27, -2.0, v27
    v_cvt_pk_bf16_f32 v26, v26, v27
    v_lshrrev_b32 v27, 16, v26
    buffer_store_short v26, v4, s[12:15], s42 offen
    buffer_store_short v27, v4, s[12:15], s42 offen offset:1280
    s_add_u32 s42, s42, 2560
    v_mul_f32 v28, v16, v22
    v_fma_f32 v28, -v17, v23, v28
    v_mul_f32 v29, v16, v23
    v_fma_f32 v23, v17, v22, v29
    v_mov_b32 v22, v28
    s_waitcnt vmcnt(15)
    v_lshlrev_b32 v26, 16, v48
    v_and_b32 v27, 0xffff0000, v48
    v_add_f32 v26, v26, v22
    v_add_f32 v27, v27, v23
    v_add_f32 v26, v26, v26
    v_mul_f32 v27, -2.0, v27
    v_cvt_pk_bf16_f32 v26, v26, v27
    v_lshrrev_b32 v27, 16, v26
    buffer_store_short v26, v4, s[12:15], s42 offen
    buffer_store_short v27, v4, s[12:15], s42 offen offset:1280
    s_add_u32 s42, s42, 2560
    v_mul_f32 v28, v16, v22
    v_fma_f32 v28, -v17, v23, v28
    v_mul_f32 v29, v16, v23
    v_fma_f32 v23, v17, v22, v29
    v_mov_b32 v22, v28
    s_waitcnt vmcnt(14)
    v_lshlrev_b32 v26, 16, v49
    v_and_b32 v27, 0xffff0000, v49
    v_add_f32 v26, v26, v22
    v_add_f32 v27, v27, v23
    v_add_f32 v26, v26, v26
    v_mul_f32 v27, -2.0, v27
    v_cvt_pk_bf16_f32 v26, v26, v27
    v_lshrrev_b32 v27, 16, v26
    buffer_store_short v26, v4, s[12:15], s42 offen
    buffer_store_short v27, v4, s[12:15], s42 offen offset:1280
    s_add_u32 s42, s42, 2560
    v_mul_f32 v28, v16, v22
    v_fma_f32 v28, -v17, v23, v28
    v_mul_f32 v29, v16, v23
    v_fma_f32 v23, v17, v22, v29
    v_mov_b32 v22, v28
    s_waitcnt vmcnt(13)
    v_lshlrev_b32 v26, 16, v50
    v_and_b32 v27, 0xffff0000, v50
    v_add_f32 v26, v26, v22
    v_add_f32 v27, v27, v23
    v_add_f32 v26, v26, v26
    v_mul_f32 v27, -2.0, v27
    v_cvt_pk_bf16_f32 v26, v26, v27
    v_lshrrev_b32 v27, 16, v26
    buffer_store_short v26, v4, s[12:15], s42 offen
    buffer_store_short v27, v4, s[12:15], s42 offen offset:1280
    s_add_u32 s42, s42, 2560
    v_mul_f32 v28, v16, v22
    v_fma_f32 v28, -v17, v23, v28
    v_mul_f32 v29, v16, v23
    v_fma_f32 v23, v17, v22, v29
    v_mov_b32 v22, v28
    s_waitcnt vmcnt(12)
    v_lshlrev_b32 v26, 16, v51
    v_and_b32 v27, 0xffff0000, v51
    v_add_f32 v26, v26, v22
    v_add_f32 v27, v27, v23
    v_add_f32 v26, v26, v26
    v_mul_f32 v27, -2.0, v27
    v_cvt_pk_bf16_f32 v26, v26, v27
    v_lshrrev_b32 v27, 16, v26
    buffer_store_short v26, v4, s[12:15], s42 offen
    buffer_store_short v27, v4, s[12:15], s42 offen offset:1280
    s_add_u32 s42, s42, 2560
    v_mul_f32 v28, v16, v22
    v_fma_f32 v28, -v17, v23, v28
    v_mul_f32 v29, v16, v23
    v_fma_f32 v23, v17, v22, v29
    v_mov_b32 v22, v28
    s_waitcnt vmcnt(11)
    v_lshlrev_b32 v26, 16, v52
    v_and_b32 v27, 0xffff0000, v52
    v_add_f32 v26, v26, v22
    v_add_f32 v27, v27, v23
    v_add_f32 v26, v26, v26
    v_mul_f32 v27, -2.0, v27
    v_cvt_pk_bf16_f32 v26, v26, v27
    v_lshrrev_b32 v27, 16, v26
    buffer_store_short v26, v4, s[12:15], s42 offen
    buffer_store_short v27, v4, s[12:15], s42 offen offset:1280
    s_add_u32 s42, s42, 2560
    v_mul_f32 v28, v16, v22
    v_fma_f32 v28, -v17, v23, v28
    v_mul_f32 v29, v16, v23
    v_fma_f32 v23, v17, v22, v29
    v_mov_b32 v22, v28
    s_waitcnt vmcnt(10)
    v_lshlrev_b32 v26, 16, v53
    v_and_b32 v27, 0xffff0000, v53
    v_add_f32 v26, v26, v22
    v_add_f32 v27, v27, v23
    v_add_f32 v26, v26, v26
    v_mul_f32 v27, -2.0, v27
    v_cvt_pk_bf16_f32 v26, v26, v27
    v_lshrrev_b32 v27, 16, v26
    buffer_store_short v26, v4, s[12:15], s42 offen
    buffer_store_short v27, v4, s[12:15], s42 offen offset:1280
    s_add_u32 s42, s42, 2560
    v_mul_f32 v28, v16, v22
    v_fma_f32 v28, -v17, v23, v28
    v_mul_f32 v29, v16, v23
    v_fma_f32 v23, v17, v22, v29
    v_mov_b32 v22, v28
    s_waitcnt vmcnt(9)
    v_lshlrev_b32 v26, 16, v54
    v_and_b32 v27, 0xffff0000, v54
    v_add_f32 v26, v26, v22
    v_add_f32 v27, v27, v23
    v_add_f32 v26, v26, v26
    v_mul_f32 v27, -2.0, v27
    v_cvt_pk_bf16_f32 v26, v26, v27
    v_lshrrev_b32 v27, 16, v26
    buffer_store_short v26, v4, s[12:15], s42 offen
    buffer_store_short v27, v4, s[12:15], s42 offen offset:1280
    s_add_u32 s42, s42, 2560
    v_mul_f32 v28, v16, v22
    v_fma_f32 v28, -v17, v23, v28
    v_mul_f32 v29, v16, v23
    v_fma_f32 v23, v17, v22, v29
    v_mov_b32 v22, v28
    s_waitcnt vmcnt(8)
    v_lshlrev_b32 v26, 16, v55
    v_and_b32 v27, 0xffff0000, v55
    v_add_f32 v26, v26, v22
    v_add_f32 v27, v27, v23
    v_add_f32 v26, v26, v26
    v_mul_f32 v27, -2.0, v27
    v_cvt_pk_bf16_f32 v26, v26, v27
    v_lshrrev_b32 v27, 16, v26
    buffer_store_short v26, v4, s[12:15], s42 offen
    buffer_store_short v27, v4, s[12:15], s42 offen offset:1280
    s_add_u32 s42, s42, 2560
    v_mul_f32 v28, v16, v22
    v_fma_f32 v28, -v17, v23, v28
    v_mul_f32 v29, v16, v23
    v_fma_f32 v23, v17, v22, v29
    v_mov_b32 v22, v28
    s_waitcnt vmcnt(7)
    v_lshlrev_b32 v26, 16, v56
    v_and_b32 v27, 0xffff0000, v56
    v_add_f32 v26, v26, v22
    v_add_f32 v27, v27, v23
    v_add_f32 v26, v26, v26
    v_mul_f32 v27, -2.0, v27
    v_cvt_pk_bf16_f32 v26, v26, v27
    v_lshrrev_b32 v27, 16, v26
    buffer_store_short v26, v4, s[12:15], s42 offen
    buffer_store_short v27, v4, s[12:15], s42 offen offset:1280
    s_add_u32 s42, s42, 2560
    v_mul_f32 v28, v16, v22
    v_fma_f32 v28, -v17, v23, v28
    v_mul_f32 v29, v16, v23
    v_fma_f32 v23, v17, v22, v29
    v_mov_b32 v22, v28
    s_waitcnt vmcnt(6)
    v_lshlrev_b32 v26, 16, v57
    v_and_b32 v27, 0xffff0000, v57
    v_add_f32 v26, v26, v22
    v_add_f32 v27, v27, v23
    v_add_f32 v26, v26, v26
    v_mul_f32 v27, -2.0, v27
    v_cvt_pk_bf16_f32 v26, v26, v27
    v_lshrrev_b32 v27, 16, v26
    buffer_store_short v26, v4, s[12:15], s42 offen
    buffer_store_short v27, v4, s[12:15], s42 offen offset:1280
    s_add_u32 s42, s42, 2560
    v_mul_f32 v28, v16, v22
    v_fma_f32 v28, -v17, v23, v28
    v_mul_f32 v29, v16, v23
    v_fma_f32 v23, v17, v22, v29
    v_mov_b32 v22, v28
    s_waitcnt vmcnt(5)
    v_lshlrev_b32 v26, 16, v58
    v_and_b32 v27, 0xffff0000, v58
    v_add_f32 v26, v26, v22
    v_add_f32 v27, v27, v23
    v_add_f32 v26, v26, v26
    v_mul_f32 v27, -2.0, v27
    v_cvt_pk_bf16_f32 v26, v26, v27
    v_lshrrev_b32 v27, 16, v26
    buffer_store_short v26, v4, s[12:15], s42 offen
    buffer_store_short v27, v4, s[12:15], s42 offen offset:1280
    s_add_u32 s42, s42, 2560
    v_mul_f32 v28, v16, v22
    v_fma_f32 v28, -v17, v23, v28
    v_mul_f32 v29, v16, v23
    v_fma_f32 v23, v17, v22, v29
    v_mov_b32 v22, v28
    s_waitcnt vmcnt(4)
    v_lshlrev_b32 v26, 16, v59
    v_and_b32 v27, 0xffff0000, v59
    v_add_f32 v26, v26, v22
    v_add_f32 v27, v27, v23
    v_add_f32 v26, v26, v26
    v_mul_f32 v27, -2.0, v27
    v_cvt_pk_bf16_f32 v26, v26, v27
    v_lshrrev_b32 v27, 16, v26
    buffer_store_short v26, v4, s[12:15], s42 offen
    buffer_store_short v27, v4, s[12:15], s42 offen offset:1280
    s_add_u32 s42, s42, 2560
    v_mul_f32 v28, v16, v22
    v_fma_f32 v28, -v17, v23, v28
    v_mul_f32 v29, v16, v23
    v_fma_f32 v23, v17, v22, v29
    v_mov_b32 v22, v28
    s_waitcnt vmcnt(3)
    v_lshlrev_b32 v26, 16, v60
    v_and_b32 v27, 0xffff0000, v60
    v_add_f32 v26, v26, v22
    v_add_f32 v27, v27, v23
    v_add_f32 v26, v26, v26
    v_mul_f32 v27, -2.0, v27
    v_cvt_pk_bf16_f32 v26, v26, v27
    v_lshrrev_b32 v27, 16, v26
    buffer_store_short v26, v4, s[12:15], s42 offen
    buffer_store_short v27, v4, s[12:15], s42 offen offset:1280
    s_add_u32 s42, s42, 2560
    v_mul_f32 v28, v16, v22
    v_fma_f32 v28, -v17, v23, v28
    v_mul_f32 v29, v16, v23
    v_fma_f32 v23, v17, v22, v29
    v_mov_b32 v22, v28
    s_waitcnt vmcnt(2)
    v_lshlrev_b32 v26, 16, v61
    v_and_b32 v27, 0xffff0000, v61
    v_add_f32 v26, v26, v22
    v_add_f32 v27, v27, v23
    v_add_f32 v26, v26, v26
    v_mul_f32 v27, -2.0, v27
    v_cvt_pk_bf16_f32 v26, v26, v27
    v_lshrrev_b32 v27, 16, v26
    buffer_store_short v26, v4, s[12:15], s42 offen
    buffer_store_short v27, v4, s[12:15], s42 offen offset:1280
    s_add_u32 s42, s42, 2560
    v_mul_f32 v28, v16, v22
    v_fma_f32 v28, -v17, v23, v28
    v_mul_f32 v29, v16, v23
    v_fma_f32 v23, v17, v22, v29
    v_mov_b32 v22, v28
    s_waitcnt vmcnt(1)
    v_lshlrev_b32 v26, 16, v62
    v_and_b32 v27, 0xffff0000, v62
    v_add_f32 v26, v26, v22
    v_add_f32 v27, v27, v23
    v_add_f32 v26, v26, v26
    v_mul_f32 v27, -2.0, v27
    v_cvt_pk_bf16_f32 v26, v26, v27
    v_lshrrev_b32 v27, 16, v26
    buffer_store_short v26, v4, s[12:15], s42 offen
    buffer_store_short v27, v4, s[12:15], s42 offen offset:1280
    s_add_u32 s42, s42, 2560
    v_mul_f32 v28, v16, v22
    v_fma_f32 v28, -v17, v23, v28
    v_mul_f32 v29, v16, v23
    v_fma_f32 v23, v17, v22, v29
    v_mov_b32 v22, v28
    s_waitcnt vmcnt(0)
    v_lshlrev_b32 v26, 16, v63
    v_and_b32 v27, 0xffff0000, v63
    v_add_f32 v26, v26, v22
    v_add_f32 v27, v27, v23
    v_add_f32 v26, v26, v26
    v_mul_f32 v27, -2.0, v27
    v_cvt_pk_bf16_f32 v26, v26, v27
    v_lshrrev_b32 v27, 16, v26
    buffer_store_short v26, v4, s[12:15], s42 offen
    buffer_store_short v27, v4, s[12:15], s42 offen offset:1280
    s_add_u32 s42, s42, 2560
    v_mul_f32 v28, v16, v22
    v_fma_f32 v28, -v17, v23, v28
    v_mul_f32 v29, v16, v23
    v_fma_f32 v23, v17, v22, v29
    v_mov_b32 v22, v28
    s_branch K2_END
K2_GATE:
    s_sub_u32 s36, s2, 320
    s_mov_b32 s4, s44
    s_and_b32 s5, s45, 0xffff
    s_mov_b32 s6, 2621440
    s_mov_b32 s7, 0x00020000
    s_mov_b32 s8, s60
    s_and_b32 s9, s61, 0xffff
    s_mov_b32 s10, 1280
    s_mov_b32 s11, 0x00020000
    s_add_u32 s64, s62, 18874368
    s_addc_u32 s65, s63, 0
    s_mov_b32 s12, s64
    s_and_b32 s13, s65, 0xffff
    s_mov_b32 s14, 8192
    s_mov_b32 s15, 0x00020000
    v_and_b32 v1, 63, v0
    v_lshrrev_b32 v2, 6, v0
    v_lshlrev_b32 v3, 2, v1
    buffer_load_dword v8, v3, s[8:11], 0 offen offset:0
    buffer_load_dword v9, v3, s[8:11], 0 offen offset:256
    buffer_load_dword v10, v3, s[8:11], 0 offen offset:512
    buffer_load_dword v11, v3, s[8:11], 0 offen offset:768
    buffer_load_dword v12, v3, s[8:11], 0 offen offset:1024
    s_lshl_b32 s41, s36, 4
    v_lshl_add_u32 v4, v2, 3, s41
    v_mul_u32_u24 v5, 1280, v4
    v_add_u32 v5, v5, v3
    buffer_load_dword v16, v5, s[4:7], 0 offen offset:0
    buffer_load_dword v17, v5, s[4:7], 0 offen offset:256
    buffer_load_dword v18, v5, s[4:7], 0 offen offset:512
    buffer_load_dword v19, v5, s[4:7], 0 offen offset:768
    buffer_load_dword v20, v5, s[4:7], 0 offen offset:1024
    v_add_u32 v5, 1280, v5
    s_waitcnt vmcnt(0)
    v_mov_b32 v30, 0
    v_lshlrev_b32 v24, 16, v16
    v_lshlrev_b32 v25, 16, v8
    v_mul_f32 v24, v24, v25
    v_cvt_pk_bf16_f32 v24, v24, v24
    v_lshlrev_b32 v24, 16, v24
    v_add_f32 v30, v30, v24
    v_and_b32 v24, 0xffff0000, v16
    v_and_b32 v25, 0xffff0000, v8
    v_mul_f32 v24, v24, v25
    v_cvt_pk_bf16_f32 v24, v24, v24
    v_lshlrev_b32 v24, 16, v24
    v_add_f32 v30, v30, v24
    v_lshlrev_b32 v24, 16, v17
    v_lshlrev_b32 v25, 16, v9
    v_mul_f32 v24, v24, v25
    v_cvt_pk_bf16_f32 v24, v24, v24
    v_lshlrev_b32 v24, 16, v24
    v_add_f32 v30, v30, v24
    v_and_b32 v24, 0xffff0000, v17
    v_and_b32 v25, 0xffff0000, v9
    v_mul_f32 v24, v24, v25
    v_cvt_pk_bf16_f32 v24, v24, v24
    v_lshlrev_b32 v24, 16, v24
    v_add_f32 v30, v30, v24
    v_lshlrev_b32 v24, 16, v18
    v_lshlrev_b32 v25, 16, v10
    v_mul_f32 v24, v24, v25
    v_cvt_pk_bf16_f32 v24, v24, v24
    v_lshlrev_b32 v24, 16, v24
    v_add_f32 v30, v30, v24
    v_and_b32 v24, 0xffff0000, v18
    v_and_b32 v25, 0xffff0000, v10
    v_mul_f32 v24, v24, v25
    v_cvt_pk_bf16_f32 v24, v24, v24
    v_lshlrev_b32 v24, 16, v24
    v_add_f32 v30, v30, v24
    v_lshlrev_b32 v24, 16, v19
    v_lshlrev_b32 v25, 16, v11
    v_mul_f32 v24, v24, v25
    v_cvt_pk_bf16_f32 v24, v24, v24
    v_lshlrev_b32 v24, 16, v24
    v_add_f32 v30, v30, v24
    v_and_b32 v24, 0xffff0000, v19
    v_and_b32 v25, 0xffff0000, v11
    v_mul_f32 v24, v24, v25
    v_cvt_pk_bf16_f32 v24, v24, v24
    v_lshlrev_b32 v24, 16, v24
    v_add_f32 v30, v30, v24
    v_lshlrev_b32 v24, 16, v20
    v_lshlrev_b32 v25, 16, v12
    v_mul_f32 v24, v24, v25
    v_cvt_pk_bf16_f32 v24, v24, v24
    v_lshlrev_b32 v24, 16, v24
    v_add_f32 v30, v30, v24
    v_and_b32 v24, 0xffff0000, v20
    v_and_b32 v25, 0xffff0000, v12
    v_mul_f32 v24, v24, v25
    v_cvt_pk_bf16_f32 v24, v24, v24
    v_lshlrev_b32 v24, 16, v24
    v_add_f32 v30, v30, v24
    ds_swizzle_b32 v24, v30 offset:1055
    s_waitcnt lgkmcnt(0)
    v_add_f32 v30, v30, v24
    ds_swizzle_b32 v24, v30 offset:2079
    s_waitcnt lgkmcnt(0)
    v_add_f32 v30, v30, v24
    ds_swizzle_b32 v24, v30 offset:4127
    s_waitcnt lgkmcnt(0)
    v_add_f32 v30, v30, v24
    ds_swizzle_b32 v24, v30 offset:8223
    s_waitcnt lgkmcnt(0)
    v_add_f32 v30, v30, v24
    ds_swizzle_b32 v24, v30 offset:16415
    s_waitcnt lgkmcnt(0)
    v_add_f32 v30, v30, v24
    s_nop 0
    v_readlane_b32 s42, v30, 32
    s_nop 1
    v_add_f32 v30, s42, v30
    v_cvt_pk_bf16_f32 v30, v30, v30
    v_lshlrev_b32 v30, 16, v30
    v_mul_f32 v30, 0xbfb8aa3b, v30
    v_exp_f32 v30, v30
    s_nop 1
    v_add_f32 v30, 1.0, v30
    v_rcp_f32 v30, v30
    s_nop 1
    v_cvt_pk_bf16_f32 v30, v30, v30
    v_lshlrev_b32 v30, 16, v30
    v_add_u32 v24, 0, v4
    v_lshlrev_b32 v24, 2, v24
    v_cmp_eq_u32 vcc, 0, v1
    s_and_saveexec_b64 s[66:67], vcc
    buffer_store_dword v30, v24, s[12:15], 0 offen
    s_mov_b64 exec, s[66:67]
    buffer_load_dword v16, v5, s[4:7], 0 offen offset:0
    buffer_load_dword v17, v5, s[4:7], 0 offen offset:256
    buffer_load_dword v18, v5, s[4:7], 0 offen offset:512
    buffer_load_dword v19, v5, s[4:7], 0 offen offset:768
    buffer_load_dword v20, v5, s[4:7], 0 offen offset:1024
    v_add_u32 v5, 1280, v5
    s_waitcnt vmcnt(0)
    v_mov_b32 v30, 0
    v_lshlrev_b32 v24, 16, v16
    v_lshlrev_b32 v25, 16, v8
    v_mul_f32 v24, v24, v25
    v_cvt_pk_bf16_f32 v24, v24, v24
    v_lshlrev_b32 v24, 16, v24
    v_add_f32 v30, v30, v24
    v_and_b32 v24, 0xffff0000, v16
    v_and_b32 v25, 0xffff0000, v8
    v_mul_f32 v24, v24, v25
    v_cvt_pk_bf16_f32 v24, v24, v24
    v_lshlrev_b32 v24, 16, v24
    v_add_f32 v30, v30, v24
    v_lshlrev_b32 v24, 16, v17
    v_lshlrev_b32 v25, 16, v9
    v_mul_f32 v24, v24, v25
    v_cvt_pk_bf16_f32 v24, v24, v24
    v_lshlrev_b32 v24, 16, v24
    v_add_f32 v30, v30, v24
    v_and_b32 v24, 0xffff0000, v17
    v_and_b32 v25, 0xffff0000, v9
    v_mul_f32 v24, v24, v25
    v_cvt_pk_bf16_f32 v24, v24, v24
    v_lshlrev_b32 v24, 16, v24
    v_add_f32 v30, v30, v24
    v_lshlrev_b32 v24, 16, v18
    v_lshlrev_b32 v25, 16, v10
    v_mul_f32 v24, v24, v25
    v_cvt_pk_bf16_f32 v24, v24, v24
    v_lshlrev_b32 v24, 16, v24
    v_add_f32 v30, v30, v24
    v_and_b32 v24, 0xffff0000, v18
    v_and_b32 v25, 0xffff0000, v10
    v_mul_f32 v24, v24, v25
    v_cvt_pk_bf16_f32 v24, v24, v24
    v_lshlrev_b32 v24, 16, v24
    v_add_f32 v30, v30, v24
    v_lshlrev_b32 v24, 16, v19
    v_lshlrev_b32 v25, 16, v11
    v_mul_f32 v24, v24, v25
    v_cvt_pk_bf16_f32 v24, v24, v24
    v_lshlrev_b32 v24, 16, v24
    v_add_f32 v30, v30, v24
    v_and_b32 v24, 0xffff0000, v19
    v_and_b32 v25, 0xffff0000, v11
    v_mul_f32 v24, v24, v25
    v_cvt_pk_bf16_f32 v24, v24, v24
    v_lshlrev_b32 v24, 16, v24
    v_add_f32 v30, v30, v24
    v_lshlrev_b32 v24, 16, v20
    v_lshlrev_b32 v25, 16, v12
    v_mul_f32 v24, v24, v25
    v_cvt_pk_bf16_f32 v24, v24, v24
    v_lshlrev_b32 v24, 16, v24
    v_add_f32 v30, v30, v24
    v_and_b32 v24, 0xffff0000, v20
    v_and_b32 v25, 0xffff0000, v12
    v_mul_f32 v24, v24, v25
    v_cvt_pk_bf16_f32 v24, v24, v24
    v_lshlrev_b32 v24, 16, v24
    v_add_f32 v30, v30, v24
    ds_swizzle_b32 v24, v30 offset:1055
    s_waitcnt lgkmcnt(0)
    v_add_f32 v30, v30, v24
    ds_swizzle_b32 v24, v30 offset:2079
    s_waitcnt lgkmcnt(0)
    v_add_f32 v30, v30, v24
    ds_swizzle_b32 v24, v30 offset:4127
    s_waitcnt lgkmcnt(0)
    v_add_f32 v30, v30, v24
    ds_swizzle_b32 v24, v30 offset:8223
    s_waitcnt lgkmcnt(0)
    v_add_f32 v30, v30, v24
    ds_swizzle_b32 v24, v30 offset:16415
    s_waitcnt lgkmcnt(0)
    v_add_f32 v30, v30, v24
    s_nop 0
    v_readlane_b32 s42, v30, 32
    s_nop 1
    v_add_f32 v30, s42, v30
    v_cvt_pk_bf16_f32 v30, v30, v30
    v_lshlrev_b32 v30, 16, v30
    v_mul_f32 v30, 0xbfb8aa3b, v30
    v_exp_f32 v30, v30
    s_nop 1
    v_add_f32 v30, 1.0, v30
    v_rcp_f32 v30, v30
    s_nop 1
    v_cvt_pk_bf16_f32 v30, v30, v30
    v_lshlrev_b32 v30, 16, v30
    v_add_u32 v24, 1, v4
    v_lshlrev_b32 v24, 2, v24
    v_cmp_eq_u32 vcc, 0, v1
    s_and_saveexec_b64 s[66:67], vcc
    buffer_store_dword v30, v24, s[12:15], 0 offen
    s_mov_b64 exec, s[66:67]
    buffer_load_dword v16, v5, s[4:7], 0 offen offset:0
    buffer_load_dword v17, v5, s[4:7], 0 offen offset:256
    buffer_load_dword v18, v5, s[4:7], 0 offen offset:512
    buffer_load_dword v19, v5, s[4:7], 0 offen offset:768
    buffer_load_dword v20, v5, s[4:7], 0 offen offset:1024
    v_add_u32 v5, 1280, v5
    s_waitcnt vmcnt(0)
    v_mov_b32 v30, 0
    v_lshlrev_b32 v24, 16, v16
    v_lshlrev_b32 v25, 16, v8
    v_mul_f32 v24, v24, v25
    v_cvt_pk_bf16_f32 v24, v24, v24
    v_lshlrev_b32 v24, 16, v24
    v_add_f32 v30, v30, v24
    v_and_b32 v24, 0xffff0000, v16
    v_and_b32 v25, 0xffff0000, v8
    v_mul_f32 v24, v24, v25
    v_cvt_pk_bf16_f32 v24, v24, v24
    v_lshlrev_b32 v24, 16, v24
    v_add_f32 v30, v30, v24
    v_lshlrev_b32 v24, 16, v17
    v_lshlrev_b32 v25, 16, v9
    v_mul_f32 v24, v24, v25
    v_cvt_pk_bf16_f32 v24, v24, v24
    v_lshlrev_b32 v24, 16, v24
    v_add_f32 v30, v30, v24
    v_and_b32 v24, 0xffff0000, v17
    v_and_b32 v25, 0xffff0000, v9
    v_mul_f32 v24, v24, v25
    v_cvt_pk_bf16_f32 v24, v24, v24
    v_lshlrev_b32 v24, 16, v24
    v_add_f32 v30, v30, v24
    v_lshlrev_b32 v24, 16, v18
    v_lshlrev_b32 v25, 16, v10
    v_mul_f32 v24, v24, v25
    v_cvt_pk_bf16_f32 v24, v24, v24
    v_lshlrev_b32 v24, 16, v24
    v_add_f32 v30, v30, v24
    v_and_b32 v24, 0xffff0000, v18
    v_and_b32 v25, 0xffff0000, v10
    v_mul_f32 v24, v24, v25
    v_cvt_pk_bf16_f32 v24, v24, v24
    v_lshlrev_b32 v24, 16, v24
    v_add_f32 v30, v30, v24
    v_lshlrev_b32 v24, 16, v19
    v_lshlrev_b32 v25, 16, v11
    v_mul_f32 v24, v24, v25
    v_cvt_pk_bf16_f32 v24, v24, v24
    v_lshlrev_b32 v24, 16, v24
    v_add_f32 v30, v30, v24
    v_and_b32 v24, 0xffff0000, v19
    v_and_b32 v25, 0xffff0000, v11
    v_mul_f32 v24, v24, v25
    v_cvt_pk_bf16_f32 v24, v24, v24
    v_lshlrev_b32 v24, 16, v24
    v_add_f32 v30, v30, v24
    v_lshlrev_b32 v24, 16, v20
    v_lshlrev_b32 v25, 16, v12
    v_mul_f32 v24, v24, v25
    v_cvt_pk_bf16_f32 v24, v24, v24
    v_lshlrev_b32 v24, 16, v24
    v_add_f32 v30, v30, v24
    v_and_b32 v24, 0xffff0000, v20
    v_and_b32 v25, 0xffff0000, v12
    v_mul_f32 v24, v24, v25
    v_cvt_pk_bf16_f32 v24, v24, v24
    v_lshlrev_b32 v24, 16, v24
    v_add_f32 v30, v30, v24
    ds_swizzle_b32 v24, v30 offset:1055
    s_waitcnt lgkmcnt(0)
    v_add_f32 v30, v30, v24
    ds_swizzle_b32 v24, v30 offset:2079
    s_waitcnt lgkmcnt(0)
    v_add_f32 v30, v30, v24
    ds_swizzle_b32 v24, v30 offset:4127
    s_waitcnt lgkmcnt(0)
    v_add_f32 v30, v30, v24
    ds_swizzle_b32 v24, v30 offset:8223
    s_waitcnt lgkmcnt(0)
    v_add_f32 v30, v30, v24
    ds_swizzle_b32 v24, v30 offset:16415
    s_waitcnt lgkmcnt(0)
    v_add_f32 v30, v30, v24
    s_nop 0
    v_readlane_b32 s42, v30, 32
    s_nop 1
    v_add_f32 v30, s42, v30
    v_cvt_pk_bf16_f32 v30, v30, v30
    v_lshlrev_b32 v30, 16, v30
    v_mul_f32 v30, 0xbfb8aa3b, v30
    v_exp_f32 v30, v30
    s_nop 1
    v_add_f32 v30, 1.0, v30
    v_rcp_f32 v30, v30
    s_nop 1
    v_cvt_pk_bf16_f32 v30, v30, v30
    v_lshlrev_b32 v30, 16, v30
    v_add_u32 v24, 2, v4
    v_lshlrev_b32 v24, 2, v24
    v_cmp_eq_u32 vcc, 0, v1
    s_and_saveexec_b64 s[66:67], vcc
    buffer_store_dword v30, v24, s[12:15], 0 offen
    s_mov_b64 exec, s[66:67]
    buffer_load_dword v16, v5, s[4:7], 0 offen offset:0
    buffer_load_dword v17, v5, s[4:7], 0 offen offset:256
    buffer_load_dword v18, v5, s[4:7], 0 offen offset:512
    buffer_load_dword v19, v5, s[4:7], 0 offen offset:768
    buffer_load_dword v20, v5, s[4:7], 0 offen offset:1024
    v_add_u32 v5, 1280, v5
    s_waitcnt vmcnt(0)
    v_mov_b32 v30, 0
    v_lshlrev_b32 v24, 16, v16
    v_lshlrev_b32 v25, 16, v8
    v_mul_f32 v24, v24, v25
    v_cvt_pk_bf16_f32 v24, v24, v24
    v_lshlrev_b32 v24, 16, v24
    v_add_f32 v30, v30, v24
    v_and_b32 v24, 0xffff0000, v16
    v_and_b32 v25, 0xffff0000, v8
    v_mul_f32 v24, v24, v25
    v_cvt_pk_bf16_f32 v24, v24, v24
    v_lshlrev_b32 v24, 16, v24
    v_add_f32 v30, v30, v24
    v_lshlrev_b32 v24, 16, v17
    v_lshlrev_b32 v25, 16, v9
    v_mul_f32 v24, v24, v25
    v_cvt_pk_bf16_f32 v24, v24, v24
    v_lshlrev_b32 v24, 16, v24
    v_add_f32 v30, v30, v24
    v_and_b32 v24, 0xffff0000, v17
    v_and_b32 v25, 0xffff0000, v9
    v_mul_f32 v24, v24, v25
    v_cvt_pk_bf16_f32 v24, v24, v24
    v_lshlrev_b32 v24, 16, v24
    v_add_f32 v30, v30, v24
    v_lshlrev_b32 v24, 16, v18
    v_lshlrev_b32 v25, 16, v10
    v_mul_f32 v24, v24, v25
    v_cvt_pk_bf16_f32 v24, v24, v24
    v_lshlrev_b32 v24, 16, v24
    v_add_f32 v30, v30, v24
    v_and_b32 v24, 0xffff0000, v18
    v_and_b32 v25, 0xffff0000, v10
    v_mul_f32 v24, v24, v25
    v_cvt_pk_bf16_f32 v24, v24, v24
    v_lshlrev_b32 v24, 16, v24
    v_add_f32 v30, v30, v24
    v_lshlrev_b32 v24, 16, v19
    v_lshlrev_b32 v25, 16, v11
    v_mul_f32 v24, v24, v25
    v_cvt_pk_bf16_f32 v24, v24, v24
    v_lshlrev_b32 v24, 16, v24
    v_add_f32 v30, v30, v24
    v_and_b32 v24, 0xffff0000, v19
    v_and_b32 v25, 0xffff0000, v11
    v_mul_f32 v24, v24, v25
    v_cvt_pk_bf16_f32 v24, v24, v24
    v_lshlrev_b32 v24, 16, v24
    v_add_f32 v30, v30, v24
    v_lshlrev_b32 v24, 16, v20
    v_lshlrev_b32 v25, 16, v12
    v_mul_f32 v24, v24, v25
    v_cvt_pk_bf16_f32 v24, v24, v24
    v_lshlrev_b32 v24, 16, v24
    v_add_f32 v30, v30, v24
    v_and_b32 v24, 0xffff0000, v20
    v_and_b32 v25, 0xffff0000, v12
    v_mul_f32 v24, v24, v25
    v_cvt_pk_bf16_f32 v24, v24, v24
    v_lshlrev_b32 v24, 16, v24
    v_add_f32 v30, v30, v24
    ds_swizzle_b32 v24, v30 offset:1055
    s_waitcnt lgkmcnt(0)
    v_add_f32 v30, v30, v24
    ds_swizzle_b32 v24, v30 offset:2079
    s_waitcnt lgkmcnt(0)
    v_add_f32 v30, v30, v24
    ds_swizzle_b32 v24, v30 offset:4127
    s_waitcnt lgkmcnt(0)
    v_add_f32 v30, v30, v24
    ds_swizzle_b32 v24, v30 offset:8223
    s_waitcnt lgkmcnt(0)
    v_add_f32 v30, v30, v24
    ds_swizzle_b32 v24, v30 offset:16415
    s_waitcnt lgkmcnt(0)
    v_add_f32 v30, v30, v24
    s_nop 0
    v_readlane_b32 s42, v30, 32
    s_nop 1
    v_add_f32 v30, s42, v30
    v_cvt_pk_bf16_f32 v30, v30, v30
    v_lshlrev_b32 v30, 16, v30
    v_mul_f32 v30, 0xbfb8aa3b, v30
    v_exp_f32 v30, v30
    s_nop 1
    v_add_f32 v30, 1.0, v30
    v_rcp_f32 v30, v30
    s_nop 1
    v_cvt_pk_bf16_f32 v30, v30, v30
    v_lshlrev_b32 v30, 16, v30
    v_add_u32 v24, 3, v4
    v_lshlrev_b32 v24, 2, v24
    v_cmp_eq_u32 vcc, 0, v1
    s_and_saveexec_b64 s[66:67], vcc
    buffer_store_dword v30, v24, s[12:15], 0 offen
    s_mov_b64 exec, s[66:67]
    buffer_load_dword v16, v5, s[4:7], 0 offen offset:0
    buffer_load_dword v17, v5, s[4:7], 0 offen offset:256
    buffer_load_dword v18, v5, s[4:7], 0 offen offset:512
    buffer_load_dword v19, v5, s[4:7], 0 offen offset:768
    buffer_load_dword v20, v5, s[4:7], 0 offen offset:1024
    v_add_u32 v5, 1280, v5
    s_waitcnt vmcnt(0)
    v_mov_b32 v30, 0
    v_lshlrev_b32 v24, 16, v16
    v_lshlrev_b32 v25, 16, v8
    v_mul_f32 v24, v24, v25
    v_cvt_pk_bf16_f32 v24, v24, v24
    v_lshlrev_b32 v24, 16, v24
    v_add_f32 v30, v30, v24
    v_and_b32 v24, 0xffff0000, v16
    v_and_b32 v25, 0xffff0000, v8
    v_mul_f32 v24, v24, v25
    v_cvt_pk_bf16_f32 v24, v24, v24
    v_lshlrev_b32 v24, 16, v24
    v_add_f32 v30, v30, v24
    v_lshlrev_b32 v24, 16, v17
    v_lshlrev_b32 v25, 16, v9
    v_mul_f32 v24, v24, v25
    v_cvt_pk_bf16_f32 v24, v24, v24
    v_lshlrev_b32 v24, 16, v24
    v_add_f32 v30, v30, v24
    v_and_b32 v24, 0xffff0000, v17
    v_and_b32 v25, 0xffff0000, v9
    v_mul_f32 v24, v24, v25
    v_cvt_pk_bf16_f32 v24, v24, v24
    v_lshlrev_b32 v24, 16, v24
    v_add_f32 v30, v30, v24
    v_lshlrev_b32 v24, 16, v18
    v_lshlrev_b32 v25, 16, v10
    v_mul_f32 v24, v24, v25
    v_cvt_pk_bf16_f32 v24, v24, v24
    v_lshlrev_b32 v24, 16, v24
    v_add_f32 v30, v30, v24
    v_and_b32 v24, 0xffff0000, v18
    v_and_b32 v25, 0xffff0000, v10
    v_mul_f32 v24, v24, v25
    v_cvt_pk_bf16_f32 v24, v24, v24
    v_lshlrev_b32 v24, 16, v24
    v_add_f32 v30, v30, v24
    v_lshlrev_b32 v24, 16, v19
    v_lshlrev_b32 v25, 16, v11
    v_mul_f32 v24, v24, v25
    v_cvt_pk_bf16_f32 v24, v24, v24
    v_lshlrev_b32 v24, 16, v24
    v_add_f32 v30, v30, v24
    v_and_b32 v24, 0xffff0000, v19
    v_and_b32 v25, 0xffff0000, v11
    v_mul_f32 v24, v24, v25
    v_cvt_pk_bf16_f32 v24, v24, v24
    v_lshlrev_b32 v24, 16, v24
    v_add_f32 v30, v30, v24
    v_lshlrev_b32 v24, 16, v20
    v_lshlrev_b32 v25, 16, v12
    v_mul_f32 v24, v24, v25
    v_cvt_pk_bf16_f32 v24, v24, v24
    v_lshlrev_b32 v24, 16, v24
    v_add_f32 v30, v30, v24
    v_and_b32 v24, 0xffff0000, v20
    v_and_b32 v25, 0xffff0000, v12
    v_mul_f32 v24, v24, v25
    v_cvt_pk_bf16_f32 v24, v24, v24
    v_lshlrev_b32 v24, 16, v24
    v_add_f32 v30, v30, v24
    ds_swizzle_b32 v24, v30 offset:1055
    s_waitcnt lgkmcnt(0)
    v_add_f32 v30, v30, v24
    ds_swizzle_b32 v24, v30 offset:2079
    s_waitcnt lgkmcnt(0)
    v_add_f32 v30, v30, v24
    ds_swizzle_b32 v24, v30 offset:4127
    s_waitcnt lgkmcnt(0)
    v_add_f32 v30, v30, v24
    ds_swizzle_b32 v24, v30 offset:8223
    s_waitcnt lgkmcnt(0)
    v_add_f32 v30, v30, v24
    ds_swizzle_b32 v24, v30 offset:16415
    s_waitcnt lgkmcnt(0)
    v_add_f32 v30, v30, v24
    s_nop 0
    v_readlane_b32 s42, v30, 32
    s_nop 1
    v_add_f32 v30, s42, v30
    v_cvt_pk_bf16_f32 v30, v30, v30
    v_lshlrev_b32 v30, 16, v30
    v_mul_f32 v30, 0xbfb8aa3b, v30
    v_exp_f32 v30, v30
    s_nop 1
    v_add_f32 v30, 1.0, v30
    v_rcp_f32 v30, v30
    s_nop 1
    v_cvt_pk_bf16_f32 v30, v30, v30
    v_lshlrev_b32 v30, 16, v30
    v_add_u32 v24, 4, v4
    v_lshlrev_b32 v24, 2, v24
    v_cmp_eq_u32 vcc, 0, v1
    s_and_saveexec_b64 s[66:67], vcc
    buffer_store_dword v30, v24, s[12:15], 0 offen
    s_mov_b64 exec, s[66:67]
    buffer_load_dword v16, v5, s[4:7], 0 offen offset:0
    buffer_load_dword v17, v5, s[4:7], 0 offen offset:256
    buffer_load_dword v18, v5, s[4:7], 0 offen offset:512
    buffer_load_dword v19, v5, s[4:7], 0 offen offset:768
    buffer_load_dword v20, v5, s[4:7], 0 offen offset:1024
    v_add_u32 v5, 1280, v5
    s_waitcnt vmcnt(0)
    v_mov_b32 v30, 0
    v_lshlrev_b32 v24, 16, v16
    v_lshlrev_b32 v25, 16, v8
    v_mul_f32 v24, v24, v25
    v_cvt_pk_bf16_f32 v24, v24, v24
    v_lshlrev_b32 v24, 16, v24
    v_add_f32 v30, v30, v24
    v_and_b32 v24, 0xffff0000, v16
    v_and_b32 v25, 0xffff0000, v8
    v_mul_f32 v24, v24, v25
    v_cvt_pk_bf16_f32 v24, v24, v24
    v_lshlrev_b32 v24, 16, v24
    v_add_f32 v30, v30, v24
    v_lshlrev_b32 v24, 16, v17
    v_lshlrev_b32 v25, 16, v9
    v_mul_f32 v24, v24, v25
    v_cvt_pk_bf16_f32 v24, v24, v24
    v_lshlrev_b32 v24, 16, v24
    v_add_f32 v30, v30, v24
    v_and_b32 v24, 0xffff0000, v17
    v_and_b32 v25, 0xffff0000, v9
    v_mul_f32 v24, v24, v25
    v_cvt_pk_bf16_f32 v24, v24, v24
    v_lshlrev_b32 v24, 16, v24
    v_add_f32 v30, v30, v24
    v_lshlrev_b32 v24, 16, v18
    v_lshlrev_b32 v25, 16, v10
    v_mul_f32 v24, v24, v25
    v_cvt_pk_bf16_f32 v24, v24, v24
    v_lshlrev_b32 v24, 16, v24
    v_add_f32 v30, v30, v24
    v_and_b32 v24, 0xffff0000, v18
    v_and_b32 v25, 0xffff0000, v10
    v_mul_f32 v24, v24, v25
    v_cvt_pk_bf16_f32 v24, v24, v24
    v_lshlrev_b32 v24, 16, v24
    v_add_f32 v30, v30, v24
    v_lshlrev_b32 v24, 16, v19
    v_lshlrev_b32 v25, 16, v11
    v_mul_f32 v24, v24, v25
    v_cvt_pk_bf16_f32 v24, v24, v24
    v_lshlrev_b32 v24, 16, v24
    v_add_f32 v30, v30, v24
    v_and_b32 v24, 0xffff0000, v19
    v_and_b32 v25, 0xffff0000, v11
    v_mul_f32 v24, v24, v25
    v_cvt_pk_bf16_f32 v24, v24, v24
    v_lshlrev_b32 v24, 16, v24
    v_add_f32 v30, v30, v24
    v_lshlrev_b32 v24, 16, v20
    v_lshlrev_b32 v25, 16, v12
    v_mul_f32 v24, v24, v25
    v_cvt_pk_bf16_f32 v24, v24, v24
    v_lshlrev_b32 v24, 16, v24
    v_add_f32 v30, v30, v24
    v_and_b32 v24, 0xffff0000, v20
    v_and_b32 v25, 0xffff0000, v12
    v_mul_f32 v24, v24, v25
    v_cvt_pk_bf16_f32 v24, v24, v24
    v_lshlrev_b32 v24, 16, v24
    v_add_f32 v30, v30, v24
    ds_swizzle_b32 v24, v30 offset:1055
    s_waitcnt lgkmcnt(0)
    v_add_f32 v30, v30, v24
    ds_swizzle_b32 v24, v30 offset:2079
    s_waitcnt lgkmcnt(0)
    v_add_f32 v30, v30, v24
    ds_swizzle_b32 v24, v30 offset:4127
    s_waitcnt lgkmcnt(0)
    v_add_f32 v30, v30, v24
    ds_swizzle_b32 v24, v30 offset:8223
    s_waitcnt lgkmcnt(0)
    v_add_f32 v30, v30, v24
    ds_swizzle_b32 v24, v30 offset:16415
    s_waitcnt lgkmcnt(0)
    v_add_f32 v30, v30, v24
    s_nop 0
    v_readlane_b32 s42, v30, 32
    s_nop 1
    v_add_f32 v30, s42, v30
    v_cvt_pk_bf16_f32 v30, v30, v30
    v_lshlrev_b32 v30, 16, v30
    v_mul_f32 v30, 0xbfb8aa3b, v30
    v_exp_f32 v30, v30
    s_nop 1
    v_add_f32 v30, 1.0, v30
    v_rcp_f32 v30, v30
    s_nop 1
    v_cvt_pk_bf16_f32 v30, v30, v30
    v_lshlrev_b32 v30, 16, v30
    v_add_u32 v24, 5, v4
    v_lshlrev_b32 v24, 2, v24
    v_cmp_eq_u32 vcc, 0, v1
    s_and_saveexec_b64 s[66:67], vcc
    buffer_store_dword v30, v24, s[12:15], 0 offen
    s_mov_b64 exec, s[66:67]
    buffer_load_dword v16, v5, s[4:7], 0 offen offset:0
    buffer_load_dword v17, v5, s[4:7], 0 offen offset:256
    buffer_load_dword v18, v5, s[4:7], 0 offen offset:512
    buffer_load_dword v19, v5, s[4:7], 0 offen offset:768
    buffer_load_dword v20, v5, s[4:7], 0 offen offset:1024
    v_add_u32 v5, 1280, v5
    s_waitcnt vmcnt(0)
    v_mov_b32 v30, 0
    v_lshlrev_b32 v24, 16, v16
    v_lshlrev_b32 v25, 16, v8
    v_mul_f32 v24, v24, v25
    v_cvt_pk_bf16_f32 v24, v24, v24
    v_lshlrev_b32 v24, 16, v24
    v_add_f32 v30, v30, v24
    v_and_b32 v24, 0xffff0000, v16
    v_and_b32 v25, 0xffff0000, v8
    v_mul_f32 v24, v24, v25
    v_cvt_pk_bf16_f32 v24, v24, v24
    v_lshlrev_b32 v24, 16, v24
    v_add_f32 v30, v30, v24
    v_lshlrev_b32 v24, 16, v17
    v_lshlrev_b32 v25, 16, v9
    v_mul_f32 v24, v24, v25
    v_cvt_pk_bf16_f32 v24, v24, v24
    v_lshlrev_b32 v24, 16, v24
    v_add_f32 v30, v30, v24
    v_and_b32 v24, 0xffff0000, v17
    v_and_b32 v25, 0xffff0000, v9
    v_mul_f32 v24, v24, v25
    v_cvt_pk_bf16_f32 v24, v24, v24
    v_lshlrev_b32 v24, 16, v24
    v_add_f32 v30, v30, v24
    v_lshlrev_b32 v24, 16, v18
    v_lshlrev_b32 v25, 16, v10
    v_mul_f32 v24, v24, v25
    v_cvt_pk_bf16_f32 v24, v24, v24
    v_lshlrev_b32 v24, 16, v24
    v_add_f32 v30, v30, v24
    v_and_b32 v24, 0xffff0000, v18
    v_and_b32 v25, 0xffff0000, v10
    v_mul_f32 v24, v24, v25
    v_cvt_pk_bf16_f32 v24, v24, v24
    v_lshlrev_b32 v24, 16, v24
    v_add_f32 v30, v30, v24
    v_lshlrev_b32 v24, 16, v19
    v_lshlrev_b32 v25, 16, v11
    v_mul_f32 v24, v24, v25
    v_cvt_pk_bf16_f32 v24, v24, v24
    v_lshlrev_b32 v24, 16, v24
    v_add_f32 v30, v30, v24
    v_and_b32 v24, 0xffff0000, v19
    v_and_b32 v25, 0xffff0000, v11
    v_mul_f32 v24, v24, v25
    v_cvt_pk_bf16_f32 v24, v24, v24
    v_lshlrev_b32 v24, 16, v24
    v_add_f32 v30, v30, v24
    v_lshlrev_b32 v24, 16, v20
    v_lshlrev_b32 v25, 16, v12
    v_mul_f32 v24, v24, v25
    v_cvt_pk_bf16_f32 v24, v24, v24
    v_lshlrev_b32 v24, 16, v24
    v_add_f32 v30, v30, v24
    v_and_b32 v24, 0xffff0000, v20
    v_and_b32 v25, 0xffff0000, v12
    v_mul_f32 v24, v24, v25
    v_cvt_pk_bf16_f32 v24, v24, v24
    v_lshlrev_b32 v24, 16, v24
    v_add_f32 v30, v30, v24
    ds_swizzle_b32 v24, v30 offset:1055
    s_waitcnt lgkmcnt(0)
    v_add_f32 v30, v30, v24
    ds_swizzle_b32 v24, v30 offset:2079
    s_waitcnt lgkmcnt(0)
    v_add_f32 v30, v30, v24
    ds_swizzle_b32 v24, v30 offset:4127
    s_waitcnt lgkmcnt(0)
    v_add_f32 v30, v30, v24
    ds_swizzle_b32 v24, v30 offset:8223
    s_waitcnt lgkmcnt(0)
    v_add_f32 v30, v30, v24
    ds_swizzle_b32 v24, v30 offset:16415
    s_waitcnt lgkmcnt(0)
    v_add_f32 v30, v30, v24
    s_nop 0
    v_readlane_b32 s42, v30, 32
    s_nop 1
    v_add_f32 v30, s42, v30
    v_cvt_pk_bf16_f32 v30, v30, v30
    v_lshlrev_b32 v30, 16, v30
    v_mul_f32 v30, 0xbfb8aa3b, v30
    v_exp_f32 v30, v30
    s_nop 1
    v_add_f32 v30, 1.0, v30
    v_rcp_f32 v30, v30
    s_nop 1
    v_cvt_pk_bf16_f32 v30, v30, v30
    v_lshlrev_b32 v30, 16, v30
    v_add_u32 v24, 6, v4
    v_lshlrev_b32 v24, 2, v24
    v_cmp_eq_u32 vcc, 0, v1
    s_and_saveexec_b64 s[66:67], vcc
    buffer_store_dword v30, v24, s[12:15], 0 offen
    s_mov_b64 exec, s[66:67]
    buffer_load_dword v16, v5, s[4:7], 0 offen offset:0
    buffer_load_dword v17, v5, s[4:7], 0 offen offset:256
    buffer_load_dword v18, v5, s[4:7], 0 offen offset:512
    buffer_load_dword v19, v5, s[4:7], 0 offen offset:768
    buffer_load_dword v20, v5, s[4:7], 0 offen offset:1024
    v_add_u32 v5, 1280, v5
    s_waitcnt vmcnt(0)
    v_mov_b32 v30, 0
    v_lshlrev_b32 v24, 16, v16
    v_lshlrev_b32 v25, 16, v8
    v_mul_f32 v24, v24, v25
    v_cvt_pk_bf16_f32 v24, v24, v24
    v_lshlrev_b32 v24, 16, v24
    v_add_f32 v30, v30, v24
    v_and_b32 v24, 0xffff0000, v16
    v_and_b32 v25, 0xffff0000, v8
    v_mul_f32 v24, v24, v25
    v_cvt_pk_bf16_f32 v24, v24, v24
    v_lshlrev_b32 v24, 16, v24
    v_add_f32 v30, v30, v24
    v_lshlrev_b32 v24, 16, v17
    v_lshlrev_b32 v25, 16, v9
    v_mul_f32 v24, v24, v25
    v_cvt_pk_bf16_f32 v24, v24, v24
    v_lshlrev_b32 v24, 16, v24
    v_add_f32 v30, v30, v24
    v_and_b32 v24, 0xffff0000, v17
    v_and_b32 v25, 0xffff0000, v9
    v_mul_f32 v24, v24, v25
    v_cvt_pk_bf16_f32 v24, v24, v24
    v_lshlrev_b32 v24, 16, v24
    v_add_f32 v30, v30, v24
    v_lshlrev_b32 v24, 16, v18
    v_lshlrev_b32 v25, 16, v10
    v_mul_f32 v24, v24, v25
    v_cvt_pk_bf16_f32 v24, v24, v24
    v_lshlrev_b32 v24, 16, v24
    v_add_f32 v30, v30, v24
    v_and_b32 v24, 0xffff0000, v18
    v_and_b32 v25, 0xffff0000, v10
    v_mul_f32 v24, v24, v25
    v_cvt_pk_bf16_f32 v24, v24, v24
    v_lshlrev_b32 v24, 16, v24
    v_add_f32 v30, v30, v24
    v_lshlrev_b32 v24, 16, v19
    v_lshlrev_b32 v25, 16, v11
    v_mul_f32 v24, v24, v25
    v_cvt_pk_bf16_f32 v24, v24, v24
    v_lshlrev_b32 v24, 16, v24
    v_add_f32 v30, v30, v24
    v_and_b32 v24, 0xffff0000, v19
    v_and_b32 v25, 0xffff0000, v11
    v_mul_f32 v24, v24, v25
    v_cvt_pk_bf16_f32 v24, v24, v24
    v_lshlrev_b32 v24, 16, v24
    v_add_f32 v30, v30, v24
    v_lshlrev_b32 v24, 16, v20
    v_lshlrev_b32 v25, 16, v12
    v_mul_f32 v24, v24, v25
    v_cvt_pk_bf16_f32 v24, v24, v24
    v_lshlrev_b32 v24, 16, v24
    v_add_f32 v30, v30, v24
    v_and_b32 v24, 0xffff0000, v20
    v_and_b32 v25, 0xffff0000, v12
    v_mul_f32 v24, v24, v25
    v_cvt_pk_bf16_f32 v24, v24, v24
    v_lshlrev_b32 v24, 16, v24
    v_add_f32 v30, v30, v24
    ds_swizzle_b32 v24, v30 offset:1055
    s_waitcnt lgkmcnt(0)
    v_add_f32 v30, v30, v24
    ds_swizzle_b32 v24, v30 offset:2079
    s_waitcnt lgkmcnt(0)
    v_add_f32 v30, v30, v24
    ds_swizzle_b32 v24, v30 offset:4127
    s_waitcnt lgkmcnt(0)
    v_add_f32 v30, v30, v24
    ds_swizzle_b32 v24, v30 offset:8223
    s_waitcnt lgkmcnt(0)
    v_add_f32 v30, v30, v24
    ds_swizzle_b32 v24, v30 offset:16415
    s_waitcnt lgkmcnt(0)
    v_add_f32 v30, v30, v24
    s_nop 0
    v_readlane_b32 s42, v30, 32
    s_nop 1
    v_add_f32 v30, s42, v30
    v_cvt_pk_bf16_f32 v30, v30, v30
    v_lshlrev_b32 v30, 16, v30
    v_mul_f32 v30, 0xbfb8aa3b, v30
    v_exp_f32 v30, v30
    s_nop 1
    v_add_f32 v30, 1.0, v30
    v_rcp_f32 v30, v30
    s_nop 1
    v_cvt_pk_bf16_f32 v30, v30, v30
    v_lshlrev_b32 v30, 16, v30
    v_add_u32 v24, 7, v4
    v_lshlrev_b32 v24, 2, v24
    v_cmp_eq_u32 vcc, 0, v1
    s_and_saveexec_b64 s[66:67], vcc
    buffer_store_dword v30, v24, s[12:15], 0 offen
    s_mov_b64 exec, s[66:67]
K2_END:
    s_endpgm
.section .rodata,"a"
.p2align 6
.amdhsa_kernel k2_kernel
  .amdhsa_next_free_vgpr 64
  .amdhsa_next_free_sgpr 96
  .amdhsa_accum_offset 64
  .amdhsa_group_segment_fixed_size 0
  .amdhsa_kernarg_size 128
  .amdhsa_user_sgpr_count 2
  .amdhsa_user_sgpr_kernarg_segment_ptr 1
  .amdhsa_system_sgpr_workgroup_id_x 1
.end_amdhsa_kernel
.text
.globl k3_kernel
.p2align 8
.type k3_kernel,@function
k3_kernel:
    s_cmp_ge_u32 s2, 256
    s_cbranch_scc1 K3_END
    s_load_dwordx16 s[44:59], s[0:1], 0
    s_load_dwordx4 s[60:63], s[0:1], 88
    s_load_dwordx4 s[64:67], s[0:1], 104
    s_load_dwordx2 s[68:69], s[0:1], 120
    s_load_dwordx2 s[70:71], s[0:1], 64
    v_lshrrev_b32 v1, 6, v0
    v_and_b32 v2, 63, v0
    s_nop 0
    v_readfirstlane_b32 s36, v1
    s_and_b32 s37, s2, 31
    s_lshr_b32 s38, s2, 5
    v_and_b32 v3, 15, v2
    v_lshrrev_b32 v4, 4, v2
    s_waitcnt lgkmcnt(0)
    v_mov_b32 v128, 0
    v_mov_b32 v129, 0
    v_mov_b32 v130, 0
    v_mov_b32 v131, 0
    v_mov_b32 v132, 0
    v_mov_b32 v133, 0
    v_mov_b32 v134, 0
    v_mov_b32 v135, 0
    v_mov_b32 v136, 0
    v_mov_b32 v137, 0
    v_mov_b32 v138, 0
    v_mov_b32 v139, 0
    v_mov_b32 v140, 0
    v_mov_b32 v141, 0
    v_mov_b32 v142, 0
    v_mov_b32 v143, 0
    v_mov_b32 v144, 0
    v_mov_b32 v145, 0
    v_mov_b32 v146, 0
    v_mov_b32 v147, 0
    v_mov_b32 v148, 0
    v_mov_b32 v149, 0
    v_mov_b32 v150, 0
    v_mov_b32 v151, 0
    v_mov_b32 v152, 0
    v_mov_b32 v153, 0
    v_mov_b32 v154, 0
    v_mov_b32 v155, 0
    v_mov_b32 v156, 0
    v_mov_b32 v157, 0
    v_mov_b32 v158, 0
    v_mov_b32 v159, 0
    v_mov_b32 v160, 0
    v_mov_b32 v161, 0
    v_mov_b32 v162, 0
    v_mov_b32 v163, 0
    v_mov_b32 v164, 0
    v_mov_b32 v165, 0
    v_mov_b32 v166, 0
    v_mov_b32 v167, 0
    v_mov_b32 v168, 0
    v_mov_b32 v169, 0
    v_mov_b32 v170, 0
    v_mov_b32 v171, 0
    v_mov_b32 v172, 0
    v_mov_b32 v173, 0
    v_mov_b32 v174, 0
    v_mov_b32 v175, 0
    v_mov_b32 v176, 0
    v_mov_b32 v177, 0
    v_mov_b32 v178, 0
    v_mov_b32 v179, 0
    v_mov_b32 v180, 0
    v_mov_b32 v181, 0
    v_mov_b32 v182, 0
    v_mov_b32 v183, 0
    v_mov_b32 v184, 0
    v_mov_b32 v185, 0
    v_mov_b32 v186, 0
    v_mov_b32 v187, 0
    v_mov_b32 v188, 0
    v_mov_b32 v189, 0
    v_mov_b32 v190, 0
    v_mov_b32 v191, 0
    v_mov_b32 v192, 0
    v_mov_b32 v193, 0
    v_mov_b32 v194, 0
    v_mov_b32 v195, 0
    v_mov_b32 v196, 0
    v_mov_b32 v197, 0
    v_mov_b32 v198, 0
    v_mov_b32 v199, 0
    v_mov_b32 v200, 0
    v_mov_b32 v201, 0
    v_mov_b32 v202, 0
    v_mov_b32 v203, 0
    v_mov_b32 v204, 0
    v_mov_b32 v205, 0
    v_mov_b32 v206, 0
    v_mov_b32 v207, 0
    s_mul_i32 s74, s36, 20736
    v_lshrrev_b32 v240, 3, v2
    v_and_b32 v241, 7, v2
    v_mul_u32_u24 v242, 144, v240
    v_lshl_add_u32 v242, v241, 4, v242
    v_add_u32 v248, s74, v242
    v_mul_u32_u24 v242, 144, v3
    v_lshl_add_u32 v242, v4, 4, v242
    v_add_u32 v249, s74, v242
    s_cmp_ge_u32 s36, 2
    s_cbranch_scc1 K3_BW
    s_add_u32 s72, s68, 13631488
    s_addc_u32 s73, s69, 0
    s_mov_b32 s4, s72
    s_and_b32 s5, s73, 0xffff
    s_mov_b32 s6, 5242880
    s_mov_b32 s7, 0x00020000
    s_cmp_eq_u32 s36, 0
    s_cselect_b32 s72, s54, s56
    s_cselect_b32 s73, s55, s57
    s_mov_b32 s8, s72
    s_and_b32 s9, s73, 0xffff
    s_mov_b32 s10, 819200
    s_mov_b32 s11, 0x00020000
    s_lshl_b32 s41, s37, 6
    v_add_u32 v5, s41, v240
    v_mul_u32_u24 v5, 2560, v5
    v_lshl_add_u32 v5, v241, 4, v5
    s_mul_i32 s41, s36, 1280
    v_add_u32 v5, s41, v5
    s_mul_i32 s41, s38, 80
    v_add_u32 v6, s41, v240
    v_mul_u32_u24 v6, 1280, v6
    v_lshl_add_u32 v6, v241, 4, v6
    s_mov_b32 s40, 0
    s_mov_b32 s42, 10
    s_mov_b32 s75, 20480
    s_mov_b32 s76, 10240
    s_mov_b32 s77, s40
    buffer_load_dwordx4 v[16:19], v5, s[4:7], s77 offen
    s_add_u32 s77, s77, 20480
    buffer_load_dwordx4 v[20:23], v5, s[4:7], s77 offen
    s_add_u32 s77, s77, 20480
    buffer_load_dwordx4 v[24:27], v5, s[4:7], s77 offen
    s_add_u32 s77, s77, 20480
    buffer_load_dwordx4 v[28:31], v5, s[4:7], s77 offen
    s_add_u32 s77, s77, 20480
    buffer_load_dwordx4 v[32:35], v5, s[4:7], s77 offen
    s_add_u32 s77, s77, 20480
    buffer_load_dwordx4 v[36:39], v5, s[4:7], s77 offen
    s_add_u32 s77, s77, 20480
    buffer_load_dwordx4 v[40:43], v5, s[4:7], s77 offen
    s_add_u32 s77, s77, 20480
    buffer_load_dwordx4 v[44:47], v5, s[4:7], s77 offen
    s_mov_b32 s77, s40
    buffer_load_dwordx4 v[48:51], v6, s[8:11], s77 offen
    s_add_u32 s77, s77, s76
    buffer_load_dwordx4 v[52:55], v6, s[8:11], s77 offen
    s_add_u32 s77, s77, s76
    buffer_load_dwordx4 v[56:59], v6, s[8:11], s77 offen
    s_add_u32 s77, s77, s76
    buffer_load_dwordx4 v[60:63], v6, s[8:11], s77 offen
    s_add_u32 s77, s77, s76
    buffer_load_dwordx4 v[64:67], v6, s[8:11], s77 offen
    s_add_u32 s77, s77, s76
    buffer_load_dwordx4 v[68:71], v6, s[8:11], s77 offen
    s_add_u32 s77, s77, s76
    buffer_load_dwordx4 v[72:75], v6, s[8:11], s77 offen
    s_add_u32 s77, s77, s76
    buffer_load_dwordx4 v[76:79], v6, s[8:11], s77 offen
    s_add_u32 s77, s77, s76
    buffer_load_dwordx4 v[80:83], v6, s[8:11], s77 offen
    s_add_u32 s77, s77, s76
    buffer_load_dwordx4 v[84:87], v6, s[8:11], s77 offen
    s_add_u32 s40, s40, 128
K3_AL:
    s_waitcnt vmcnt(0)
    ds_write_b128 v248, v[16:19] offset:0
    ds_write_b128 v248, v[20:23] offset:1152
    ds_write_b128 v248, v[24:27] offset:2304
    ds_write_b128 v248, v[28:31] offset:3456
    ds_write_b128 v248, v[32:35] offset:4608
    ds_write_b128 v248, v[36:39] offset:5760
    ds_write_b128 v248, v[40:43] offset:6912
    ds_write_b128 v248, v[44:47] offset:8064
    ds_write_b128 v248, v[48:51] offset:9216
    ds_write_b128 v248, v[52:55] offset:10368
    ds_write_b128 v248, v[56:59] offset:11520
    ds_write_b128 v248, v[60:63] offset:12672
    ds_write_b128 v248, v[64:67] offset:13824
    ds_write_b128 v248, v[68:71] offset:14976
    ds_write_b128 v248, v[72:75] offset:16128
    ds_write_b128 v248, v[76:79] offset:17280
    ds_write_b128 v248, v[80:83] offset:18432
    ds_write_b128 v248, v[84:87] offset:19584
    s_waitcnt lgkmcnt(0)
    s_mov_b32 s77, s40
    buffer_load_dwordx4 v[16:19], v5, s[4:7], s77 offen
    s_add_u32 s77, s77, 20480
    buffer_load_dwordx4 v[20:23], v5, s[4:7], s77 offen
    s_add_u32 s77, s77, 20480
    buffer_load_dwordx4 v[24:27], v5, s[4:7], s77 offen
    s_add_u32 s77, s77, 20480
    buffer_load_dwordx4 v[28:31], v5, s[4:7], s77 offen
    s_add_u32 s77, s77, 20480
    buffer_load_dwordx4 v[32:35], v5, s[4:7], s77 offen
    s_add_u32 s77, s77, 20480
    buffer_load_dwordx4 v[36:39], v5, s[4:7], s77 offen
    s_add_u32 s77, s77, 20480
    buffer_load_dwordx4 v[40:43], v5, s[4:7], s77 offen
    s_add_u32 s77, s77, 20480
    buffer_load_dwordx4 v[44:47], v5, s[4:7], s77 offen
    s_mov_b32 s77, s40
    buffer_load_dwordx4 v[48:51], v6, s[8:11], s77 offen
    s_add_u32 s77, s77, s76
    buffer_load_dwordx4 v[52:55], v6, s[8:11], s77 offen
    s_add_u32 s77, s77, s76
    buffer_load_dwordx4 v[56:59], v6, s[8:11], s77 offen
    s_add_u32 s77, s77, s76
    buffer_load_dwordx4 v[60:63], v6, s[8:11], s77 offen
    s_add_u32 s77, s77, s76
    buffer_load_dwordx4 v[64:67], v6, s[8:11], s77 offen
    s_add_u32 s77, s77, s76
    buffer_load_dwordx4 v[68:71], v6, s[8:11], s77 offen
    s_add_u32 s77, s77, s76
    buffer_load_dwordx4 v[72:75], v6, s[8:11], s77 offen
    s_add_u32 s77, s77, s76
    buffer_load_dwordx4 v[76:79], v6, s[8:11], s77 offen
    s_add_u32 s77, s77, s76
    buffer_load_dwordx4 v[80:83], v6, s[8:11], s77 offen
    s_add_u32 s77, s77, s76
    buffer_load_dwordx4 v[84:87], v6, s[8:11], s77 offen
    s_add_u32 s40, s40, 128
    ds_read_b128 v[88:91], v249 offset:0
    ds_read_b128 v[92:95], v249 offset:2304
    ds_read_b128 v[96:99], v249 offset:4608
    ds_read_b128 v[100:103], v249 offset:6912
    ds_read_b128 v[104:107], v249 offset:9216
    ds_read_b128 v[108:111], v249 offset:11520
    ds_read_b128 v[112:115], v249 offset:13824
    ds_read_b128 v[116:119], v249 offset:16128
    ds_read_b128 v[120:123], v249 offset:18432
    s_waitcnt lgkmcnt(0)
    v_mfma_f32_16x16x32_bf16 v[128:131], v[104:107], v[88:91], v[128:131]
    v_mfma_f32_16x16x32_bf16 v[132:135], v[108:111], v[88:91], v[132:135]
    v_mfma_f32_16x16x32_bf16 v[136:139], v[112:115], v[88:91], v[136:139]
    v_mfma_f32_16x16x32_bf16 v[140:143], v[116:119], v[88:91], v[140:143]
    v_mfma_f32_16x16x32_bf16 v[144:147], v[120:123], v[88:91], v[144:147]
    v_mfma_f32_16x16x32_bf16 v[148:151], v[104:107], v[92:95], v[148:151]
    v_mfma_f32_16x16x32_bf16 v[152:155], v[108:111], v[92:95], v[152:155]
    v_mfma_f32_16x16x32_bf16 v[156:159], v[112:115], v[92:95], v[156:159]
    v_mfma_f32_16x16x32_bf16 v[160:163], v[116:119], v[92:95], v[160:163]
    v_mfma_f32_16x16x32_bf16 v[164:167], v[120:123], v[92:95], v[164:167]
    v_mfma_f32_16x16x32_bf16 v[168:171], v[104:107], v[96:99], v[168:171]
    v_mfma_f32_16x16x32_bf16 v[172:175], v[108:111], v[96:99], v[172:175]
    v_mfma_f32_16x16x32_bf16 v[176:179], v[112:115], v[96:99], v[176:179]
    v_mfma_f32_16x16x32_bf16 v[180:183], v[116:119], v[96:99], v[180:183]
    v_mfma_f32_16x16x32_bf16 v[184:187], v[120:123], v[96:99], v[184:187]
    v_mfma_f32_16x16x32_bf16 v[188:191], v[104:107], v[100:103], v[188:191]
    v_mfma_f32_16x16x32_bf16 v[192:195], v[108:111], v[100:103], v[192:195]
    v_mfma_f32_16x16x32_bf16 v[196:199], v[112:115], v[100:103], v[196:199]
    v_mfma_f32_16x16x32_bf16 v[200:203], v[116:119], v[100:103], v[200:203]
    v_mfma_f32_16x16x32_bf16 v[204:207], v[120:123], v[100:103], v[204:207]
    ds_read_b128 v[88:91], v249 offset:64
    ds_read_b128 v[92:95], v249 offset:2368
    ds_read_b128 v[96:99], v249 offset:4672
    ds_read_b128 v[100:103], v249 offset:6976
    ds_read_b128 v[104:107], v249 offset:9280
    ds_read_b128 v[108:111], v249 offset:11584
    ds_read_b128 v[112:115], v249 offset:13888
    ds_read_b128 v[116:119], v249 offset:16192
    ds_read_b128 v[120:123], v249 offset:18496
    s_waitcnt lgkmcnt(0)
    v_mfma_f32_16x16x32_bf16 v[128:131], v[104:107], v[88:91], v[128:131]
    v_mfma_f32_16x16x32_bf16 v[132:135], v[108:111], v[88:91], v[132:135]
    v_mfma_f32_16x16x32_bf16 v[136:139], v[112:115], v[88:91], v[136:139]
    v_mfma_f32_16x16x32_bf16 v[140:143], v[116:119], v[88:91], v[140:143]
    v_mfma_f32_16x16x32_bf16 v[144:147], v[120:123], v[88:91], v[144:147]
    v_mfma_f32_16x16x32_bf16 v[148:151], v[104:107], v[92:95], v[148:151]
    v_mfma_f32_16x16x32_bf16 v[152:155], v[108:111], v[92:95], v[152:155]
    v_mfma_f32_16x16x32_bf16 v[156:159], v[112:115], v[92:95], v[156:159]
    v_mfma_f32_16x16x32_bf16 v[160:163], v[116:119], v[92:95], v[160:163]
    v_mfma_f32_16x16x32_bf16 v[164:167], v[120:123], v[92:95], v[164:167]
    v_mfma_f32_16x16x32_bf16 v[168:171], v[104:107], v[96:99], v[168:171]
    v_mfma_f32_16x16x32_bf16 v[172:175], v[108:111], v[96:99], v[172:175]
    v_mfma_f32_16x16x32_bf16 v[176:179], v[112:115], v[96:99], v[176:179]
    v_mfma_f32_16x16x32_bf16 v[180:183], v[116:119], v[96:99], v[180:183]
    v_mfma_f32_16x16x32_bf16 v[184:187], v[120:123], v[96:99], v[184:187]
    v_mfma_f32_16x16x32_bf16 v[188:191], v[104:107], v[100:103], v[188:191]
    v_mfma_f32_16x16x32_bf16 v[192:195], v[108:111], v[100:103], v[192:195]
    v_mfma_f32_16x16x32_bf16 v[196:199], v[112:115], v[100:103], v[196:199]
    v_mfma_f32_16x16x32_bf16 v[200:203], v[116:119], v[100:103], v[200:203]
    v_mfma_f32_16x16x32_bf16 v[204:207], v[120:123], v[100:103], v[204:207]
    s_sub_u32 s42, s42, 1
    s_cmp_gt_u32 s42, 0
    s_cbranch_scc1 K3_AL
    s_waitcnt vmcnt(0)
    s_branch K3_RED
K3_BW:
    s_add_u32 s72, s68, 6291456
    s_addc_u32 s73, s69, 0
    s_mov_b32 s4, s72
    s_and_b32 s5, s73, 0xffff
    s_mov_b32 s6, 7077888
    s_mov_b32 s7, 0x00020000
    s_mov_b32 s8, s60
    s_and_b32 s9, s61, 0xffff
    s_mov_b32 s10, 2211840
    s_mov_b32 s11, 0x00020000
    s_sub_u32 s43, s36, 2
    s_lshl_b32 s41, s37, 6
    v_add_u32 v5, s41, v240
    v_mul_u32_u24 v5, 3456, v5
    v_lshl_add_u32 v5, v241, 4, v5
    s_mul_i32 s41, s43, 1792
    v_add_u32 v5, s41, v5
    s_mov_b32 s41, 0x1999999a
    s_mul_i32 s72, s43, 896*1280
    s_mul_i32 s73, s38, 160
    s_add_u32 s72, s72, s73
    s_add_u32 s73, s74, 9216
    v_add_u32 v240, 0, v2
    v_mul_hi_u32 v241, v240, s41
    v_mul_u32_u24 v242, 10, v241
    v_sub_u32 v242, v240, v242
    v_mul_u32_u24 v243, 1280, v241
    v_lshl_add_u32 v243, v242, 4, v243
    v_add_u32 v208, s72, v243
    v_mul_u32_u24 v243, 176, v241
    v_lshl_add_u32 v243, v242, 4, v243
    v_add_u32 v220, s73, v243
    v_add_u32 v240, 64, v2
    v_mul_hi_u32 v241, v240, s41
    v_mul_u32_u24 v242, 10, v241
    v_sub_u32 v242, v240, v242
    v_mul_u32_u24 v243, 1280, v241
    v_lshl_add_u32 v243, v242, 4, v243
    v_add_u32 v209, s72, v243
    v_mul_u32_u24 v243, 176, v241
    v_lshl_add_u32 v243, v242, 4, v243
    v_add_u32 v221, s73, v243
    v_add_u32 v240, 128, v2
    v_mul_hi_u32 v241, v240, s41
    v_mul_u32_u24 v242, 10, v241
    v_sub_u32 v242, v240, v242
    v_mul_u32_u24 v243, 1280, v241
    v_lshl_add_u32 v243, v242, 4, v243
    v_add_u32 v210, s72, v243
    v_mul_u32_u24 v243, 176, v241
    v_lshl_add_u32 v243, v242, 4, v243
    v_add_u32 v222, s73, v243
    v_add_u32 v240, 192, v2
    v_mul_hi_u32 v241, v240, s41
    v_mul_u32_u24 v242, 10, v241
    v_sub_u32 v242, v240, v242
    v_mul_u32_u24 v243, 1280, v241
    v_lshl_add_u32 v243, v242, 4, v243
    v_add_u32 v211, s72, v243
    v_mul_u32_u24 v243, 176, v241
    v_lshl_add_u32 v243, v242, 4, v243
    v_add_u32 v223, s73, v243
    v_add_u32 v240, 256, v2
    v_mul_hi_u32 v241, v240, s41
    v_mul_u32_u24 v242, 10, v241
    v_sub_u32 v242, v240, v242
    v_mul_u32_u24 v243, 1280, v241
    v_lshl_add_u32 v243, v242, 4, v243
    v_add_u32 v212, s72, v243
    v_mul_u32_u24 v243, 176, v241
    v_lshl_add_u32 v243, v242, 4, v243
    v_add_u32 v224, s73, v243
    v_add_u32 v240, 320, v2
    v_mul_hi_u32 v241, v240, s41
    v_mul_u32_u24 v242, 10, v241
    v_sub_u32 v242, v240, v242
    v_mul_u32_u24 v243, 1280, v241
    v_lshl_add_u32 v243, v242, 4, v243
    v_add_u32 v213, s72, v243
    v_mul_u32_u24 v243, 176, v241
    v_lshl_add_u32 v243, v242, 4, v243
    v_add_u32 v225, s73, v243
    v_add_u32 v240, 384, v2
    v_mul_hi_u32 v241, v240, s41
    v_mul_u32_u24 v242, 10, v241
    v_sub_u32 v242, v240, v242
    v_mul_u32_u24 v243, 1280, v241
    v_lshl_add_u32 v243, v242, 4, v243
    v_add_u32 v214, s72, v243
    v_mul_u32_u24 v243, 176, v241
    v_lshl_add_u32 v243, v242, 4, v243
    v_add_u32 v226, s73, v243
    v_add_u32 v240, 448, v2
    v_mul_hi_u32 v241, v240, s41
    v_mul_u32_u24 v242, 10, v241
    v_sub_u32 v242, v240, v242
    v_mul_u32_u24 v243, 1280, v241
    v_lshl_add_u32 v243, v242, 4, v243
    v_add_u32 v215, s72, v243
    v_mul_u32_u24 v243, 176, v241
    v_lshl_add_u32 v243, v242, 4, v243
    v_add_u32 v227, s73, v243
    v_add_u32 v240, 512, v2
    v_mul_hi_u32 v241, v240, s41
    v_mul_u32_u24 v242, 10, v241
    v_sub_u32 v242, v240, v242
    v_mul_u32_u24 v243, 1280, v241
    v_lshl_add_u32 v243, v242, 4, v243
    v_add_u32 v216, s72, v243
    v_mul_u32_u24 v243, 176, v241
    v_lshl_add_u32 v243, v242, 4, v243
    v_add_u32 v228, s73, v243
    v_add_u32 v240, 576, v2
    v_mul_hi_u32 v241, v240, s41
    v_mul_u32_u24 v242, 10, v241
    v_sub_u32 v242, v240, v242
    v_mul_u32_u24 v243, 1280, v241
    v_lshl_add_u32 v243, v242, 4, v243
    v_add_u32 v217, s72, v243
    v_mul_u32_u24 v243, 176, v241
    v_lshl_add_u32 v243, v242, 4, v243
    v_add_u32 v229, s73, v243
    v_lshlrev_b32 v240, 3, v4
    v_bfe_u32 v241, v2, 2, 2
    v_add_u32 v240, v240, v241
    v_mul_u32_u24 v240, 176, v240
    v_and_b32 v241, 3, v2
    v_lshl_add_u32 v240, v241, 3, v240
    v_add_u32 v250, s73, v240
    s_mov_b32 s40, 0
    s_mov_b32 s39, 0
    s_sub_u32 s42, 14, s43
    s_mov_b32 s77, s40
    buffer_load_dwordx4 v[16:19], v5, s[4:7], s77 offen
    s_add_u32 s77, s77, 27648
    buffer_load_dwordx4 v[20:23], v5, s[4:7], s77 offen
    s_add_u32 s77, s77, 27648
    buffer_load_dwordx4 v[24:27], v5, s[4:7], s77 offen
    s_add_u32 s77, s77, 27648
    buffer_load_dwordx4 v[28:31], v5, s[4:7], s77 offen
    s_add_u32 s77, s77, 27648
    buffer_load_dwordx4 v[32:35], v5, s[4:7], s77 offen
    s_add_u32 s77, s77, 27648
    buffer_load_dwordx4 v[36:39], v5, s[4:7], s77 offen
    s_add_u32 s77, s77, 27648
    buffer_load_dwordx4 v[40:43], v5, s[4:7], s77 offen
    s_add_u32 s77, s77, 27648
    buffer_load_dwordx4 v[44:47], v5, s[4:7], s77 offen
    buffer_load_dwordx4 v[48:51], v208, s[8:11], s39 offen
    buffer_load_dwordx4 v[52:55], v209, s[8:11], s39 offen
    buffer_load_dwordx4 v[56:59], v210, s[8:11], s39 offen
    buffer_load_dwordx4 v[60:63], v211, s[8:11], s39 offen
    buffer_load_dwordx4 v[64:67], v212, s[8:11], s39 offen
    buffer_load_dwordx4 v[68:71], v213, s[8:11], s39 offen
    buffer_load_dwordx4 v[72:75], v214, s[8:11], s39 offen
    buffer_load_dwordx4 v[76:79], v215, s[8:11], s39 offen
    buffer_load_dwordx4 v[80:83], v216, s[8:11], s39 offen
    buffer_load_dwordx4 v[84:87], v217, s[8:11], s39 offen
    s_add_u32 s39, s39, 81920
    s_add_u32 s40, s40, 128
K3_BL:
    s_waitcnt vmcnt(0)
    ds_write_b128 v248, v[16:19] offset:0
    ds_write_b128 v248, v[20:23] offset:1152
    ds_write_b128 v248, v[24:27] offset:2304
    ds_write_b128 v248, v[28:31] offset:3456
    ds_write_b128 v248, v[32:35] offset:4608
    ds_write_b128 v248, v[36:39] offset:5760
    ds_write_b128 v248, v[40:43] offset:6912
    ds_write_b128 v248, v[44:47] offset:8064
    ds_write_b128 v220, v[48:51]
    ds_write_b128 v221, v[52:55]
    ds_write_b128 v222, v[56:59]
    ds_write_b128 v223, v[60:63]
    ds_write_b128 v224, v[64:67]
    ds_write_b128 v225, v[68:71]
    ds_write_b128 v226, v[72:75]
    ds_write_b128 v227, v[76:79]
    ds_write_b128 v228, v[80:83]
    ds_write_b128 v229, v[84:87]
    s_waitcnt lgkmcnt(0)
    s_mov_b32 s77, s40
    buffer_load_dwordx4 v[16:19], v5, s[4:7], s77 offen
    s_add_u32 s77, s77, 27648
    buffer_load_dwordx4 v[20:23], v5, s[4:7], s77 offen
    s_add_u32 s77, s77, 27648
    buffer_load_dwordx4 v[24:27], v5, s[4:7], s77 offen
    s_add_u32 s77, s77, 27648
    buffer_load_dwordx4 v[28:31], v5, s[4:7], s77 offen
    s_add_u32 s77, s77, 27648
    buffer_load_dwordx4 v[32:35], v5, s[4:7], s77 offen
    s_add_u32 s77, s77, 27648
    buffer_load_dwordx4 v[36:39], v5, s[4:7], s77 offen
    s_add_u32 s77, s77, 27648
    buffer_load_dwordx4 v[40:43], v5, s[4:7], s77 offen
    s_add_u32 s77, s77, 27648
    buffer_load_dwordx4 v[44:47], v5, s[4:7], s77 offen
    buffer_load_dwordx4 v[48:51], v208, s[8:11], s39 offen
    buffer_load_dwordx4 v[52:55], v209, s[8:11], s39 offen
    buffer_load_dwordx4 v[56:59], v210, s[8:11], s39 offen
    buffer_load_dwordx4 v[60:63], v211, s[8:11], s39 offen
    buffer_load_dwordx4 v[64:67], v212, s[8:11], s39 offen
    buffer_load_dwordx4 v[68:71], v213, s[8:11], s39 offen
    buffer_load_dwordx4 v[72:75], v214, s[8:11], s39 offen
    buffer_load_dwordx4 v[76:79], v215, s[8:11], s39 offen
    buffer_load_dwordx4 v[80:83], v216, s[8:11], s39 offen
    buffer_load_dwordx4 v[84:87], v217, s[8:11], s39 offen
    s_add_u32 s39, s39, 81920
    s_add_u32 s40, s40, 128
    ds_read_b128 v[88:91], v249 offset:0
    ds_read_b128 v[92:95], v249 offset:2304
    ds_read_b128 v[96:99], v249 offset:4608
    ds_read_b128 v[100:103], v249 offset:6912
    ds_read_b64_tr_b16 v[104:105], v250 offset:0
    ds_read_b64_tr_b16 v[106:107], v250 offset:704
    ds_read_b64_tr_b16 v[108:109], v250 offset:32
    ds_read_b64_tr_b16 v[110:111], v250 offset:736
    ds_read_b64_tr_b16 v[112:113], v250 offset:64
    ds_read_b64_tr_b16 v[114:115], v250 offset:768
    ds_read_b64_tr_b16 v[116:117], v250 offset:96
    ds_read_b64_tr_b16 v[118:119], v250 offset:800
    ds_read_b64_tr_b16 v[120:121], v250 offset:128
    ds_read_b64_tr_b16 v[122:123], v250 offset:832
    s_waitcnt lgkmcnt(0)
    v_mfma_f32_16x16x32_bf16 v[128:131], v[104:107], v[88:91], v[128:131]
    v_mfma_f32_16x16x32_bf16 v[132:135], v[108:111], v[88:91], v[132:135]
    v_mfma_f32_16x16x32_bf16 v[136:139], v[112:115], v[88:91], v[136:139]
    v_mfma_f32_16x16x32_bf16 v[140:143], v[116:119], v[88:91], v[140:143]
    v_mfma_f32_16x16x32_bf16 v[144:147], v[120:123], v[88:91], v[144:147]
    v_mfma_f32_16x16x32_bf16 v[148:151], v[104:107], v[92:95], v[148:151]
    v_mfma_f32_16x16x32_bf16 v[152:155], v[108:111], v[92:95], v[152:155]
    v_mfma_f32_16x16x32_bf16 v[156:159], v[112:115], v[92:95], v[156:159]
    v_mfma_f32_16x16x32_bf16 v[160:163], v[116:119], v[92:95], v[160:163]
    v_mfma_f32_16x16x32_bf16 v[164:167], v[120:123], v[92:95], v[164:167]
    v_mfma_f32_16x16x32_bf16 v[168:171], v[104:107], v[96:99], v[168:171]
    v_mfma_f32_16x16x32_bf16 v[172:175], v[108:111], v[96:99], v[172:175]
    v_mfma_f32_16x16x32_bf16 v[176:179], v[112:115], v[96:99], v[176:179]
    v_mfma_f32_16x16x32_bf16 v[180:183], v[116:119], v[96:99], v[180:183]
    v_mfma_f32_16x16x32_bf16 v[184:187], v[120:123], v[96:99], v[184:187]
    v_mfma_f32_16x16x32_bf16 v[188:191], v[104:107], v[100:103], v[188:191]
    v_mfma_f32_16x16x32_bf16 v[192:195], v[108:111], v[100:103], v[192:195]
    v_mfma_f32_16x16x32_bf16 v[196:199], v[112:115], v[100:103], v[196:199]
    v_mfma_f32_16x16x32_bf16 v[200:203], v[116:119], v[100:103], v[200:203]
    v_mfma_f32_16x16x32_bf16 v[204:207], v[120:123], v[100:103], v[204:207]
    ds_read_b128 v[88:91], v249 offset:64
    ds_read_b128 v[92:95], v249 offset:2368
    ds_read_b128 v[96:99], v249 offset:4672
    ds_read_b128 v[100:103], v249 offset:6976
    ds_read_b64_tr_b16 v[104:105], v250 offset:5632
    ds_read_b64_tr_b16 v[106:107], v250 offset:6336
    ds_read_b64_tr_b16 v[108:109], v250 offset:5664
    ds_read_b64_tr_b16 v[110:111], v250 offset:6368
    ds_read_b64_tr_b16 v[112:113], v250 offset:5696
    ds_read_b64_tr_b16 v[114:115], v250 offset:6400
    ds_read_b64_tr_b16 v[116:117], v250 offset:5728
    ds_read_b64_tr_b16 v[118:119], v250 offset:6432
    ds_read_b64_tr_b16 v[120:121], v250 offset:5760
    ds_read_b64_tr_b16 v[122:123], v250 offset:6464
    s_waitcnt lgkmcnt(0)
    v_mfma_f32_16x16x32_bf16 v[128:131], v[104:107], v[88:91], v[128:131]
    v_mfma_f32_16x16x32_bf16 v[132:135], v[108:111], v[88:91], v[132:135]
    v_mfma_f32_16x16x32_bf16 v[136:139], v[112:115], v[88:91], v[136:139]
    v_mfma_f32_16x16x32_bf16 v[140:143], v[116:119], v[88:91], v[140:143]
    v_mfma_f32_16x16x32_bf16 v[144:147], v[120:123], v[88:91], v[144:147]
    v_mfma_f32_16x16x32_bf16 v[148:151], v[104:107], v[92:95], v[148:151]
    v_mfma_f32_16x16x32_bf16 v[152:155], v[108:111], v[92:95], v[152:155]
    v_mfma_f32_16x16x32_bf16 v[156:159], v[112:115], v[92:95], v[156:159]
    v_mfma_f32_16x16x32_bf16 v[160:163], v[116:119], v[92:95], v[160:163]
    v_mfma_f32_16x16x32_bf16 v[164:167], v[120:123], v[92:95], v[164:167]
    v_mfma_f32_16x16x32_bf16 v[168:171], v[104:107], v[96:99], v[168:171]
    v_mfma_f32_16x16x32_bf16 v[172:175], v[108:111], v[96:99], v[172:175]
    v_mfma_f32_16x16x32_bf16 v[176:179], v[112:115], v[96:99], v[176:179]
    v_mfma_f32_16x16x32_bf16 v[180:183], v[116:119], v[96:99], v[180:183]
    v_mfma_f32_16x16x32_bf16 v[184:187], v[120:123], v[96:99], v[184:187]
    v_mfma_f32_16x16x32_bf16 v[188:191], v[104:107], v[100:103], v[188:191]
    v_mfma_f32_16x16x32_bf16 v[192:195], v[108:111], v[100:103], v[192:195]
    v_mfma_f32_16x16x32_bf16 v[196:199], v[112:115], v[100:103], v[196:199]
    v_mfma_f32_16x16x32_bf16 v[200:203], v[116:119], v[100:103], v[200:203]
    v_mfma_f32_16x16x32_bf16 v[204:207], v[120:123], v[100:103], v[204:207]
    s_sub_u32 s42, s42, 1
    s_cmp_gt_u32 s42, 0
    s_cbranch_scc1 K3_BL
    s_waitcnt vmcnt(0)
K3_RED:
    s_mov_b32 s4, s44
    s_and_b32 s5, s45, 0xffff
    s_mov_b32 s6, 2621440
    s_mov_b32 s7, 0x00020000
    s_mov_b32 s8, s70
    s_and_b32 s9, s71, 0xffff
    s_mov_b32 s10, 1280
    s_mov_b32 s11, 0x00020000
    s_mov_b32 s12, s64
    s_and_b32 s13, s65, 0xffff
    s_mov_b32 s14, 5242880
    s_mov_b32 s15, 0x00020000
    s_add_u32 s72, s68, 18874368
    s_addc_u32 s73, s69, 0
    s_mov_b32 s16, s72
    s_and_b32 s17, s73, 0xffff
    s_mov_b32 s18, 8192
    s_mov_b32 s19, 0x00020000
    s_lshl_b32 s41, s37, 6
    s_lshl_b32 s42, s36, 4
    s_add_u32 s41, s41, s42
    v_add_u32 v6, s41, v3
    s_mul_i32 s41, s38, 80
    v_lshl_add_u32 v7, v4, 2, s41
    v_lshlrev_b32 v9, 2, v6
    buffer_load_dword v10, v9, s[16:19], 0 offen
    v_mul_u32_u24 v9, 640, v6
    v_add_u32 v9, v9, v7
    v_lshlrev_b32 v11, 1, v9
    v_lshlrev_b32 v12, 2, v9
    v_lshlrev_b32 v13, 1, v7
    buffer_load_dwordx2 v[16:17], v11, s[4:7], 0 offen offset:0
    buffer_load_dwordx2 v[18:19], v13, s[8:11], 0 offen offset:0
    buffer_load_dwordx2 v[20:21], v11, s[4:7], 0 offen offset:32
    buffer_load_dwordx2 v[22:23], v13, s[8:11], 0 offen offset:32
    buffer_load_dwordx2 v[24:25], v11, s[4:7], 0 offen offset:64
    buffer_load_dwordx2 v[26:27], v13, s[8:11], 0 offen offset:64
    buffer_load_dwordx2 v[28:29], v11, s[4:7], 0 offen offset:96
    buffer_load_dwordx2 v[30:31], v13, s[8:11], 0 offen offset:96
    buffer_load_dwordx2 v[32:33], v11, s[4:7], 0 offen offset:128
    buffer_load_dwordx2 v[34:35], v13, s[8:11], 0 offen offset:128
    s_waitcnt lgkmcnt(0)
    s_barrier
    v_lshlrev_b32 v5, 4, v2
    s_mul_i32 s41, s36, 20480
    v_add_u32 v8, s41, v5
    ds_write_b128 v8, v[128:131] offset:0
    ds_write_b128 v8, v[132:135] offset:1024
    ds_write_b128 v8, v[136:139] offset:2048
    ds_write_b128 v8, v[140:143] offset:3072
    ds_write_b128 v8, v[144:147] offset:4096
    ds_write_b128 v8, v[148:151] offset:5120
    ds_write_b128 v8, v[152:155] offset:6144
    ds_write_b128 v8, v[156:159] offset:7168
    ds_write_b128 v8, v[160:163] offset:8192
    ds_write_b128 v8, v[164:167] offset:9216
    ds_write_b128 v8, v[168:171] offset:10240
    ds_write_b128 v8, v[172:175] offset:11264
    ds_write_b128 v8, v[176:179] offset:12288
    ds_write_b128 v8, v[180:183] offset:13312
    ds_write_b128 v8, v[184:187] offset:14336
    ds_write_b128 v8, v[188:191] offset:15360
    ds_write_b128 v8, v[192:195] offset:16384
    ds_write_b128 v8, v[196:199] offset:17408
    ds_write_b128 v8, v[200:203] offset:18432
    ds_write_b128 v8, v[204:207] offset:19456
    s_waitcnt lgkmcnt(0)
    s_barrier
    s_mul_i32 s41, s36, 5120
    v_add_u32 v5, s41, v5
    v_add_u32 v8, 40960, v5
    ds_read_b128 v[40:43], v5 offset:0
    ds_read_b128 v[44:47], v5 offset:20480
    ds_read_b128 v[48:51], v8 offset:0
    ds_read_b128 v[52:55], v8 offset:20480
    ds_read_b128 v[56:59], v5 offset:1024
    ds_read_b128 v[60:63], v5 offset:21504
    ds_read_b128 v[64:67], v8 offset:1024
    ds_read_b128 v[68:71], v8 offset:21504
    ds_read_b128 v[72:75], v5 offset:2048
    ds_read_b128 v[76:79], v5 offset:22528
    ds_read_b128 v[80:83], v8 offset:2048
    ds_read_b128 v[84:87], v8 offset:22528
    ds_read_b128 v[88:91], v5 offset:3072
    ds_read_b128 v[92:95], v5 offset:23552
    ds_read_b128 v[96:99], v8 offset:3072
    ds_read_b128 v[100:103], v8 offset:23552
    ds_read_b128 v[104:107], v5 offset:4096
    ds_read_b128 v[108:111], v5 offset:24576
    ds_read_b128 v[112:115], v8 offset:4096
    ds_read_b128 v[116:119], v8 offset:24576
    s_waitcnt vmcnt(0) lgkmcnt(0)
    v_sub_f32 v14, 1.0, v10
    v_cvt_pk_bf16_f32 v14, v14, v14
    v_lshlrev_b32 v14, 16, v14
    v_lshlrev_b32 v36, 16, v16
    v_lshlrev_b32 v37, 16, v18
    v_mul_f32 v36, v36, v37
    v_cvt_pk_bf16_f32 v36, v36, v36
    v_lshlrev_b32 v36, 16, v36
    v_add_f32 v36, v36, v40
    v_add_f32 v36, v36, v44
    v_add_f32 v37, v48, v52
    v_cvt_pk_bf16_f32 v37, v37, v37
    v_lshlrev_b32 v37, 16, v37
    v_mul_f32 v37, v37, v14
    v_cvt_pk_bf16_f32 v37, v37, v37
    v_lshlrev_b32 v37, 16, v37
    v_fma_f32 v40, v10, v36, v37
    v_and_b32 v36, 0xffff0000, v16
    v_and_b32 v37, 0xffff0000, v18
    v_mul_f32 v36, v36, v37
    v_cvt_pk_bf16_f32 v36, v36, v36
    v_lshlrev_b32 v36, 16, v36
    v_add_f32 v36, v36, v41
    v_add_f32 v36, v36, v45
    v_add_f32 v37, v49, v53
    v_cvt_pk_bf16_f32 v37, v37, v37
    v_lshlrev_b32 v37, 16, v37
    v_mul_f32 v37, v37, v14
    v_cvt_pk_bf16_f32 v37, v37, v37
    v_lshlrev_b32 v37, 16, v37
    v_fma_f32 v41, v10, v36, v37
    v_lshlrev_b32 v36, 16, v17
    v_lshlrev_b32 v37, 16, v19
    v_mul_f32 v36, v36, v37
    v_cvt_pk_bf16_f32 v36, v36, v36
    v_lshlrev_b32 v36, 16, v36
    v_add_f32 v36, v36, v42
    v_add_f32 v36, v36, v46
    v_add_f32 v37, v50, v54
    v_cvt_pk_bf16_f32 v37, v37, v37
    v_lshlrev_b32 v37, 16, v37
    v_mul_f32 v37, v37, v14
    v_cvt_pk_bf16_f32 v37, v37, v37
    v_lshlrev_b32 v37, 16, v37
    v_fma_f32 v42, v10, v36, v37
    v_and_b32 v36, 0xffff0000, v17
    v_and_b32 v37, 0xffff0000, v19
    v_mul_f32 v36, v36, v37
    v_cvt_pk_bf16_f32 v36, v36, v36
    v_lshlrev_b32 v36, 16, v36
    v_add_f32 v36, v36, v43
    v_add_f32 v36, v36, v47
    v_add_f32 v37, v51, v55
    v_cvt_pk_bf16_f32 v37, v37, v37
    v_lshlrev_b32 v37, 16, v37
    v_mul_f32 v37, v37, v14
    v_cvt_pk_bf16_f32 v37, v37, v37
    v_lshlrev_b32 v37, 16, v37
    v_fma_f32 v43, v10, v36, v37
    buffer_store_dwordx4 v[40:43], v12, s[12:15], 0 offen offset:0
    v_lshlrev_b32 v36, 16, v20
    v_lshlrev_b32 v37, 16, v22
    v_mul_f32 v36, v36, v37
    v_cvt_pk_bf16_f32 v36, v36, v36
    v_lshlrev_b32 v36, 16, v36
    v_add_f32 v36, v36, v56
    v_add_f32 v36, v36, v60
    v_add_f32 v37, v64, v68
    v_cvt_pk_bf16_f32 v37, v37, v37
    v_lshlrev_b32 v37, 16, v37
    v_mul_f32 v37, v37, v14
    v_cvt_pk_bf16_f32 v37, v37, v37
    v_lshlrev_b32 v37, 16, v37
    v_fma_f32 v56, v10, v36, v37
    v_and_b32 v36, 0xffff0000, v20
    v_and_b32 v37, 0xffff0000, v22
    v_mul_f32 v36, v36, v37
    v_cvt_pk_bf16_f32 v36, v36, v36
    v_lshlrev_b32 v36, 16, v36
    v_add_f32 v36, v36, v57
    v_add_f32 v36, v36, v61
    v_add_f32 v37, v65, v69
    v_cvt_pk_bf16_f32 v37, v37, v37
    v_lshlrev_b32 v37, 16, v37
    v_mul_f32 v37, v37, v14
    v_cvt_pk_bf16_f32 v37, v37, v37
    v_lshlrev_b32 v37, 16, v37
    v_fma_f32 v57, v10, v36, v37
    v_lshlrev_b32 v36, 16, v21
    v_lshlrev_b32 v37, 16, v23
    v_mul_f32 v36, v36, v37
    v_cvt_pk_bf16_f32 v36, v36, v36
    v_lshlrev_b32 v36, 16, v36
    v_add_f32 v36, v36, v58
    v_add_f32 v36, v36, v62
    v_add_f32 v37, v66, v70
    v_cvt_pk_bf16_f32 v37, v37, v37
    v_lshlrev_b32 v37, 16, v37
    v_mul_f32 v37, v37, v14
    v_cvt_pk_bf16_f32 v37, v37, v37
    v_lshlrev_b32 v37, 16, v37
    v_fma_f32 v58, v10, v36, v37
    v_and_b32 v36, 0xffff0000, v21
    v_and_b32 v37, 0xffff0000, v23
    v_mul_f32 v36, v36, v37
    v_cvt_pk_bf16_f32 v36, v36, v36
    v_lshlrev_b32 v36, 16, v36
    v_add_f32 v36, v36, v59
    v_add_f32 v36, v36, v63
    v_add_f32 v37, v67, v71
    v_cvt_pk_bf16_f32 v37, v37, v37
    v_lshlrev_b32 v37, 16, v37
    v_mul_f32 v37, v37, v14
    v_cvt_pk_bf16_f32 v37, v37, v37
    v_lshlrev_b32 v37, 16, v37
    v_fma_f32 v59, v10, v36, v37
    buffer_store_dwordx4 v[56:59], v12, s[12:15], 0 offen offset:64
    v_lshlrev_b32 v36, 16, v24
    v_lshlrev_b32 v37, 16, v26
    v_mul_f32 v36, v36, v37
    v_cvt_pk_bf16_f32 v36, v36, v36
    v_lshlrev_b32 v36, 16, v36
    v_add_f32 v36, v36, v72
    v_add_f32 v36, v36, v76
    v_add_f32 v37, v80, v84
    v_cvt_pk_bf16_f32 v37, v37, v37
    v_lshlrev_b32 v37, 16, v37
    v_mul_f32 v37, v37, v14
    v_cvt_pk_bf16_f32 v37, v37, v37
    v_lshlrev_b32 v37, 16, v37
    v_fma_f32 v72, v10, v36, v37
    v_and_b32 v36, 0xffff0000, v24
    v_and_b32 v37, 0xffff0000, v26
    v_mul_f32 v36, v36, v37
    v_cvt_pk_bf16_f32 v36, v36, v36
    v_lshlrev_b32 v36, 16, v36
    v_add_f32 v36, v36, v73
    v_add_f32 v36, v36, v77
    v_add_f32 v37, v81, v85
    v_cvt_pk_bf16_f32 v37, v37, v37
    v_lshlrev_b32 v37, 16, v37
    v_mul_f32 v37, v37, v14
    v_cvt_pk_bf16_f32 v37, v37, v37
    v_lshlrev_b32 v37, 16, v37
    v_fma_f32 v73, v10, v36, v37
    v_lshlrev_b32 v36, 16, v25
    v_lshlrev_b32 v37, 16, v27
    v_mul_f32 v36, v36, v37
    v_cvt_pk_bf16_f32 v36, v36, v36
    v_lshlrev_b32 v36, 16, v36
    v_add_f32 v36, v36, v74
    v_add_f32 v36, v36, v78
    v_add_f32 v37, v82, v86
    v_cvt_pk_bf16_f32 v37, v37, v37
    v_lshlrev_b32 v37, 16, v37
    v_mul_f32 v37, v37, v14
    v_cvt_pk_bf16_f32 v37, v37, v37
    v_lshlrev_b32 v37, 16, v37
    v_fma_f32 v74, v10, v36, v37
    v_and_b32 v36, 0xffff0000, v25
    v_and_b32 v37, 0xffff0000, v27
    v_mul_f32 v36, v36, v37
    v_cvt_pk_bf16_f32 v36, v36, v36
    v_lshlrev_b32 v36, 16, v36
    v_add_f32 v36, v36, v75
    v_add_f32 v36, v36, v79
    v_add_f32 v37, v83, v87
    v_cvt_pk_bf16_f32 v37, v37, v37
    v_lshlrev_b32 v37, 16, v37
    v_mul_f32 v37, v37, v14
    v_cvt_pk_bf16_f32 v37, v37, v37
    v_lshlrev_b32 v37, 16, v37
    v_fma_f32 v75, v10, v36, v37
    buffer_store_dwordx4 v[72:75], v12, s[12:15], 0 offen offset:128
    v_lshlrev_b32 v36, 16, v28
    v_lshlrev_b32 v37, 16, v30
    v_mul_f32 v36, v36, v37
    v_cvt_pk_bf16_f32 v36, v36, v36
    v_lshlrev_b32 v36, 16, v36
    v_add_f32 v36, v36, v88
    v_add_f32 v36, v36, v92
    v_add_f32 v37, v96, v100
    v_cvt_pk_bf16_f32 v37, v37, v37
    v_lshlrev_b32 v37, 16, v37
    v_mul_f32 v37, v37, v14
    v_cvt_pk_bf16_f32 v37, v37, v37
    v_lshlrev_b32 v37, 16, v37
    v_fma_f32 v88, v10, v36, v37
    v_and_b32 v36, 0xffff0000, v28
    v_and_b32 v37, 0xffff0000, v30
    v_mul_f32 v36, v36, v37
    v_cvt_pk_bf16_f32 v36, v36, v36
    v_lshlrev_b32 v36, 16, v36
    v_add_f32 v36, v36, v89
    v_add_f32 v36, v36, v93
    v_add_f32 v37, v97, v101
    v_cvt_pk_bf16_f32 v37, v37, v37
    v_lshlrev_b32 v37, 16, v37
    v_mul_f32 v37, v37, v14
    v_cvt_pk_bf16_f32 v37, v37, v37
    v_lshlrev_b32 v37, 16, v37
    v_fma_f32 v89, v10, v36, v37
    v_lshlrev_b32 v36, 16, v29
    v_lshlrev_b32 v37, 16, v31
    v_mul_f32 v36, v36, v37
    v_cvt_pk_bf16_f32 v36, v36, v36
    v_lshlrev_b32 v36, 16, v36
    v_add_f32 v36, v36, v90
    v_add_f32 v36, v36, v94
    v_add_f32 v37, v98, v102
    v_cvt_pk_bf16_f32 v37, v37, v37
    v_lshlrev_b32 v37, 16, v37
    v_mul_f32 v37, v37, v14
    v_cvt_pk_bf16_f32 v37, v37, v37
    v_lshlrev_b32 v37, 16, v37
    v_fma_f32 v90, v10, v36, v37
    v_and_b32 v36, 0xffff0000, v29
    v_and_b32 v37, 0xffff0000, v31
    v_mul_f32 v36, v36, v37
    v_cvt_pk_bf16_f32 v36, v36, v36
    v_lshlrev_b32 v36, 16, v36
    v_add_f32 v36, v36, v91
    v_add_f32 v36, v36, v95
    v_add_f32 v37, v99, v103
    v_cvt_pk_bf16_f32 v37, v37, v37
    v_lshlrev_b32 v37, 16, v37
    v_mul_f32 v37, v37, v14
    v_cvt_pk_bf16_f32 v37, v37, v37
    v_lshlrev_b32 v37, 16, v37
    v_fma_f32 v91, v10, v36, v37
    buffer_store_dwordx4 v[88:91], v12, s[12:15], 0 offen offset:192
    v_lshlrev_b32 v36, 16, v32
    v_lshlrev_b32 v37, 16, v34
    v_mul_f32 v36, v36, v37
    v_cvt_pk_bf16_f32 v36, v36, v36
    v_lshlrev_b32 v36, 16, v36
    v_add_f32 v36, v36, v104
    v_add_f32 v36, v36, v108
    v_add_f32 v37, v112, v116
    v_cvt_pk_bf16_f32 v37, v37, v37
    v_lshlrev_b32 v37, 16, v37
    v_mul_f32 v37, v37, v14
    v_cvt_pk_bf16_f32 v37, v37, v37
    v_lshlrev_b32 v37, 16, v37
    v_fma_f32 v104, v10, v36, v37
    v_and_b32 v36, 0xffff0000, v32
    v_and_b32 v37, 0xffff0000, v34
    v_mul_f32 v36, v36, v37
    v_cvt_pk_bf16_f32 v36, v36, v36
    v_lshlrev_b32 v36, 16, v36
    v_add_f32 v36, v36, v105
    v_add_f32 v36, v36, v109
    v_add_f32 v37, v113, v117
    v_cvt_pk_bf16_f32 v37, v37, v37
    v_lshlrev_b32 v37, 16, v37
    v_mul_f32 v37, v37, v14
    v_cvt_pk_bf16_f32 v37, v37, v37
    v_lshlrev_b32 v37, 16, v37
    v_fma_f32 v105, v10, v36, v37
    v_lshlrev_b32 v36, 16, v33
    v_lshlrev_b32 v37, 16, v35
    v_mul_f32 v36, v36, v37
    v_cvt_pk_bf16_f32 v36, v36, v36
    v_lshlrev_b32 v36, 16, v36
    v_add_f32 v36, v36, v106
    v_add_f32 v36, v36, v110
    v_add_f32 v37, v114, v118
    v_cvt_pk_bf16_f32 v37, v37, v37
    v_lshlrev_b32 v37, 16, v37
    v_mul_f32 v37, v37, v14
    v_cvt_pk_bf16_f32 v37, v37, v37
    v_lshlrev_b32 v37, 16, v37
    v_fma_f32 v106, v10, v36, v37
    v_and_b32 v36, 0xffff0000, v33
    v_and_b32 v37, 0xffff0000, v35
    v_mul_f32 v36, v36, v37
    v_cvt_pk_bf16_f32 v36, v36, v36
    v_lshlrev_b32 v36, 16, v36
    v_add_f32 v36, v36, v107
    v_add_f32 v36, v36, v111
    v_add_f32 v37, v115, v119
    v_cvt_pk_bf16_f32 v37, v37, v37
    v_lshlrev_b32 v37, 16, v37
    v_mul_f32 v37, v37, v14
    v_cvt_pk_bf16_f32 v37, v37, v37
    v_lshlrev_b32 v37, 16, v37
    v_fma_f32 v107, v10, v36, v37
    buffer_store_dwordx4 v[104:107], v12, s[12:15], 0 offen offset:256
K3_END:
    s_endpgm
.section .rodata,"a"
.p2align 6
.amdhsa_kernel k3_kernel
  .amdhsa_next_free_vgpr 256
  .amdhsa_next_free_sgpr 96
  .amdhsa_accum_offset 256
  .amdhsa_group_segment_fixed_size 0
  .amdhsa_kernarg_size 128
  .amdhsa_user_sgpr_count 2
  .amdhsa_user_sgpr_kernarg_segment_ptr 1
  .amdhsa_system_sgpr_workgroup_id_x 1
.end_amdhsa_kernel
.text
```
